```python
import torch

def _softmax(x, axis=-1):
    return torch.softmax(x, dim=axis)
def _gelu(x):
    return torch.nn.functional.gelu(x, approximate="tanh")
def _silu(x):
    return torch.nn.functional.silu(x)
def _sigmoid(x):
    return torch.sigmoid(x)
def _layernorm(x, axis=-1, eps=1e-5):
    m = x.mean(dim=axis, keepdim=True)
    v = x.var(dim=axis, keepdim=True, unbiased=False)
    return (x - m) / torch.sqrt(v + eps)
def _scatter_add(tgt, idx, src, axis=0):
    return tgt.clone().index_add_(axis, idx, src)
def _segment_sum(src, seg, n):
    out = torch.zeros((n,) + src.shape[1:], dtype=src.dtype)
    return out.index_add_(0, seg, src)
def _pad(x, pw):
    flat = tuple(v for pair in reversed(pw) for v in pair)
    return torch.nn.functional.pad(x, flat)

kernel_name = 'sequential_preLN__spectral_fnet__moe_arch_mod__prompt'

def setup_inputs():

    _w = (lambda a: (lambda t: t.to(torch.bfloat16) if t.is_floating_point() else t)(torch.as_tensor(a)))
    def _A_setup():
        B, S, D = 1, 2048, 512
        ns = torch.arange(S)[:, None] * torch.arange(S)[None, :]
        nd = torch.arange(D)[:, None] * torch.arange(D)[None, :]
        Ws_re = torch.cos(-2.0 * torch.pi * ns / S).to(float)
        Ws_im = torch.sin(-2.0 * torch.pi * ns / S).to(float)
        Wd_re = torch.cos(-2.0 * torch.pi * nd / D).to(float)
        Wd_im = torch.sin(-2.0 * torch.pi * nd / D).to(float)
        return {
            "x": _w((lambda *s: torch.randn(*s, dtype=torch.bfloat16) * 0.05)(B, S, D)),
            "dft_seq_re": _w(Ws_re),
            "dft_seq_im": _w(Ws_im),
            "dft_hid_re": _w(Wd_re),
            "dft_hid_im": _w(Wd_im),
        }
    _A_in = _A_setup()

    def _B_setup():
        B, S, D, F, C = 1, 2048, 512, 1792, 1
        return {
            "x": _w((lambda *s: torch.randn(*s, dtype=torch.bfloat16) * 0.05)(B, S, D)),
            "w_r": _w((lambda *s: torch.randn(*s, dtype=torch.bfloat16) * 1.6)(D)),
            "w_gate": _w((lambda *s: torch.randn(*s, dtype=torch.bfloat16) * 0.4)(D, F)),
            "w_up": _w((lambda *s: torch.randn(*s, dtype=torch.bfloat16) * 0.4)(D, F)),
            "w_down": _w((lambda *s: torch.randn(*s, dtype=torch.bfloat16) * 0.4)(F, D)),
        }
    _B_in = _B_setup()

    return {
        "A_x": _A_in["x"],
        "A_dft_seq_re": _A_in["dft_seq_re"],
        "A_dft_seq_im": _A_in["dft_seq_im"],
        "A_dft_hid_re": _A_in["dft_hid_re"],
        "A_dft_hid_im": _A_in["dft_hid_im"],
        "B_x": _B_in["x"],
        "B_w_r": _B_in["w_r"],
        "B_w_gate": _B_in["w_gate"],
        "B_w_up": _B_in["w_up"],
        "B_w_down": _B_in["w_down"],
    }

def reference(A_x, A_dft_seq_re, A_dft_seq_im, A_dft_hid_re, A_dft_hid_im, B_x, B_w_r, B_w_gate, B_w_up, B_w_down):
    def _A_ref(x, dft_seq_re, dft_seq_im, dft_hid_re, dft_hid_im):
        a = torch.einsum("bsd,ed->bse", x, dft_hid_re)
        b = torch.einsum("bsd,ed->bse", x, dft_hid_im)
        y = torch.einsum("ts,bse->bte", dft_seq_re, a) - torch.einsum("ts,bse->bte", dft_seq_im, b)
        return y

    def _B_ref(x, w_r, w_gate, w_up, w_down):
        B, S, D = x.shape
        C = 1
        r = x @ w_r
        idx = torch.argsort(-r, axis=-1)[:, :C]
        idx_e = (lambda x, n, axis: torch.repeat_interleave(x, n, dim=axis))(idx.reshape(B, C, 1), D, axis=2)
        x_sel = (lambda x, i, axis: torch.take_along_dim(x, i, dim=axis))(x, idx_e, axis=1)
        g = _silu(x_sel @ w_gate)
        u = x_sel @ w_up
        y = (g * u) @ w_down
        r_sel = _sigmoid((lambda x, i, axis: torch.take_along_dim(x, i, dim=axis))(r, idx, axis=1))
        y = y * r_sel.reshape(B, C, 1)
        b_off = (torch.arange(B) * S).reshape(B, 1)
        flat_idx = (idx + b_off).reshape(B * C)
        zero = (x * 0.0).reshape(B * S, D)
        upd = _scatter_add(zero, flat_idx, y.reshape(B * C, D), axis=0)
        return x + upd.reshape(B, S, D)

    x = A_x
    h = x + _A_ref(_layernorm(x, axis=-1), A_dft_seq_re, A_dft_seq_im, A_dft_hid_re, A_dft_hid_im)
    h2 = h + _B_ref(_layernorm(h, axis=-1), B_w_r, B_w_gate, B_w_up, B_w_down)
    return h2
```

```asm
; @launch kernel=kx_kernel grid=(256,1,1) block=(512,1,1) lds=163840
.amdgcn_target "amdgcn-amd-amdhsa--gfx950"
.text
.globl kx_kernel
.p2align 8
.type kx_kernel,@function
kx_kernel:
    s_cmp_ge_u32 s2, 256
    s_cbranch_scc1 kx_exit
    s_load_dwordx16 s[32:47], s[0:1], 0
    s_load_dwordx8 s[48:55], s[0:1], 64
    s_load_dwordx2 s[56:57], s[0:1], 96
    v_lshrrev_b32 v1, 6, v0
    v_and_b32 v0, 63, v0
    s_nop 0
    v_readfirstlane_b32 s16, v1
    s_and_b32 s58, s2, 7
    s_lshr_b32 s59, s2, 3
    s_and_b32 s60, s58, 1
    s_lshr_b32 s61, s58, 1
    s_and_b32 s62, s59, 3
    s_lshr_b32 s63, s59, 2
    s_lshl_b32 s67, s60, 3
    s_add_u32 s63, s63, s67
    s_lshl_b32 s64, s63, 4
    s_lshl_b32 s67, s62, 2
    s_add_u32 s64, s64, s67
    s_add_u32 s64, s64, s61
    s_lshr_b32 s65, s59, 3
    s_lshl_b32 s65, s65, 3
    s_add_u32 s65, s65, s58
    s_and_b32 s88, s61, 1
    s_lshr_b32 s89, s61, 1
    s_lshl_b32 s85, s88, 3
    s_lshl_b32 s67, s60, 2
    s_add_u32 s85, s85, s67
    s_waitcnt lgkmcnt(0)
    s_mov_b32 s68, s56
    s_and_b32 s69, s57, 0xffff
    s_mov_b32 s70, 33554432
    s_mov_b32 s71, 0x00020000
    s_mov_b32 s72, s54
    s_and_b32 s73, s55, 0xffff
    s_mov_b32 s74, 256
    s_mov_b32 s75, 0x00020000
    v_mov_b32 v197, 0
    s_cmp_lg_u32 s2, 128
    s_cbranch_scc1 kx_nononce
    s_cmp_lg_u32 s16, 0
    s_cbranch_scc1 kx_nononce
    s_memrealtime s[18:19]
    s_waitcnt lgkmcnt(0)
    s_or_b32 s84, s18, 1
    v_mov_b32 v194, s84
    s_mov_b64 exec, 1
    buffer_store_dword v194, v197, s[72:75], 0 offen sc1
    s_mov_b64 exec, -1
kx_nononce:
    s_and_b32 s86, s59, 15
    s_cmp_ge_u32 s59, 16
    s_cbranch_scc1 kx_pref
    s_and_b32 s3, s86, 3
    s_add_u32 s85, s85, s3
    s_lshr_b32 s86, s86, 2
    s_lshl_b32 s87, s89, 2
    s_add_u32 s87, s87, s86
    s_cmp_ge_u32 s16, 4
    s_cbranch_scc1 kx_loader1
    s_mov_b32 s30, 0
    s_mov_b32 s22, 8
kx_cons:
    s_lshr_b32 s17, s16, 1
    s_and_b32 s18, s16, 1
    v_and_b32 v1, 15, v0
    v_lshrrev_b32 v2, 4, v0
    v_lshrrev_b32 v3, 1, v1
    v_lshlrev_b32 v4, 7, v1
    s_lshl_b32 s19, s17, 13
    s_lshl_b32 s20, s18, 13
    s_add_u32 s20, s20, 16384
    v_add_u32 v5, 0, v2
    v_xor_b32 v5, v5, v3
    v_lshlrev_b32 v5, 4, v5
    v_add_u32 v5, v5, v4
    v_add_u32 v8, s19, v5
    v_add_u32 v12, s20, v5
    v_add_u32 v5, 4, v2
    v_xor_b32 v5, v5, v3
    v_lshlrev_b32 v5, 4, v5
    v_add_u32 v5, v5, v4
    v_add_u32 v9, s19, v5
    v_add_u32 v13, s20, v5
    s_cmp_eq_u32 s30, 0
    s_cbranch_scc1 kx_apdone
    v_and_b32 v5, 1, v2
    v_lshlrev_b32 v5, 9, v5
    v_lshrrev_b32 v6, 1, v2
    v_lshlrev_b32 v6, 8, v6
    v_lshlrev_b32 v7, 4, v1
    v_add3_u32 v5, v5, v6, v7
    v_add_u32 v8, s19, v5
    v_add_u32 v9, 1024, v8
kx_apdone:
    v_mov_b64 v[64:65], 0
    v_mov_b64 v[66:67], 0
    v_mov_b64 v[68:69], 0
    v_mov_b64 v[70:71], 0
    v_mov_b64 v[72:73], 0
    v_mov_b64 v[74:75], 0
    v_mov_b64 v[76:77], 0
    v_mov_b64 v[78:79], 0
    v_mov_b64 v[80:81], 0
    v_mov_b64 v[82:83], 0
    v_mov_b64 v[84:85], 0
    v_mov_b64 v[86:87], 0
    v_mov_b64 v[88:89], 0
    v_mov_b64 v[90:91], 0
    v_mov_b64 v[92:93], 0
    v_mov_b64 v[94:95], 0
    v_mov_b64 v[96:97], 0
    v_mov_b64 v[98:99], 0
    v_mov_b64 v[100:101], 0
    v_mov_b64 v[102:103], 0
    v_mov_b64 v[104:105], 0
    v_mov_b64 v[106:107], 0
    v_mov_b64 v[108:109], 0
    v_mov_b64 v[110:111], 0
    v_mov_b64 v[112:113], 0
    v_mov_b64 v[114:115], 0
    v_mov_b64 v[116:117], 0
    v_mov_b64 v[118:119], 0
    v_mov_b64 v[120:121], 0
    v_mov_b64 v[122:123], 0
    v_mov_b64 v[124:125], 0
    v_mov_b64 v[126:127], 0
    s_mov_b32 s23, 32768
    s_mov_b32 s24, 32768
    s_mov_b32 s25, 1
    s_mov_b32 s27, -131072
    s_mov_b32 s28, 32768
    s_barrier
    ds_read_b128 v[128:131], v8 offset:0
    ds_read_b128 v[144:147], v12 offset:0
    ds_read_b128 v[132:135], v8 offset:2048
    ds_read_b128 v[148:151], v12 offset:2048
    ds_read_b128 v[136:139], v8 offset:4096
    ds_read_b128 v[152:155], v12 offset:4096
    ds_read_b128 v[140:143], v8 offset:6144
    ds_read_b128 v[156:159], v12 offset:6144
    v_add_u32 v8, s23, v8
    v_add_u32 v12, s23, v12
kx_cloop:
    s_waitcnt lgkmcnt(0)
    v_mfma_f32_16x16x32_bf16 v[64:67], v[128:131], v[144:147], v[64:67]
    ds_read_b128 v[160:163], v9 offset:0
    v_mfma_f32_16x16x32_bf16 v[68:71], v[128:131], v[148:151], v[68:71]
    ds_read_b128 v[176:179], v13 offset:0
    v_mfma_f32_16x16x32_bf16 v[72:75], v[128:131], v[152:155], v[72:75]
    ds_read_b128 v[164:167], v9 offset:2048
    v_mfma_f32_16x16x32_bf16 v[76:79], v[128:131], v[156:159], v[76:79]
    ds_read_b128 v[180:183], v13 offset:2048
    v_mfma_f32_16x16x32_bf16 v[80:83], v[132:135], v[144:147], v[80:83]
    ds_read_b128 v[168:171], v9 offset:4096
    v_mfma_f32_16x16x32_bf16 v[84:87], v[132:135], v[148:151], v[84:87]
    ds_read_b128 v[184:187], v13 offset:4096
    v_mfma_f32_16x16x32_bf16 v[88:91], v[132:135], v[152:155], v[88:91]
    ds_read_b128 v[172:175], v9 offset:6144
    v_mfma_f32_16x16x32_bf16 v[92:95], v[132:135], v[156:159], v[92:95]
    ds_read_b128 v[188:191], v13 offset:6144
    v_mfma_f32_16x16x32_bf16 v[96:99], v[136:139], v[144:147], v[96:99]
    v_add_u32 v9, s23, v9
    v_mfma_f32_16x16x32_bf16 v[100:103], v[136:139], v[148:151], v[100:103]
    v_add_u32 v13, s23, v13
    v_mfma_f32_16x16x32_bf16 v[104:107], v[136:139], v[152:155], v[104:107]
    v_mfma_f32_16x16x32_bf16 v[108:111], v[136:139], v[156:159], v[108:111]
    v_mfma_f32_16x16x32_bf16 v[112:115], v[140:143], v[144:147], v[112:115]
    v_mfma_f32_16x16x32_bf16 v[116:119], v[140:143], v[148:151], v[116:119]
    v_mfma_f32_16x16x32_bf16 v[120:123], v[140:143], v[152:155], v[120:123]
    v_mfma_f32_16x16x32_bf16 v[124:127], v[140:143], v[156:159], v[124:127]
    s_waitcnt lgkmcnt(0)
    v_mfma_f32_16x16x32_bf16 v[64:67], v[160:163], v[176:179], v[64:67]
    ds_read_b128 v[128:131], v8 offset:0
    v_mfma_f32_16x16x32_bf16 v[68:71], v[160:163], v[180:183], v[68:71]
    ds_read_b128 v[144:147], v12 offset:0
    v_mfma_f32_16x16x32_bf16 v[72:75], v[160:163], v[184:187], v[72:75]
    ds_read_b128 v[132:135], v8 offset:2048
    v_mfma_f32_16x16x32_bf16 v[76:79], v[160:163], v[188:191], v[76:79]
    ds_read_b128 v[148:151], v12 offset:2048
    v_mfma_f32_16x16x32_bf16 v[80:83], v[164:167], v[176:179], v[80:83]
    ds_read_b128 v[136:139], v8 offset:4096
    v_mfma_f32_16x16x32_bf16 v[84:87], v[164:167], v[180:183], v[84:87]
    ds_read_b128 v[152:155], v12 offset:4096
    v_mfma_f32_16x16x32_bf16 v[88:91], v[164:167], v[184:187], v[88:91]
    ds_read_b128 v[140:143], v8 offset:6144
    v_mfma_f32_16x16x32_bf16 v[92:95], v[164:167], v[188:191], v[92:95]
    ds_read_b128 v[156:159], v12 offset:6144
    v_mfma_f32_16x16x32_bf16 v[96:99], v[168:171], v[176:179], v[96:99]
    v_add_u32 v8, s24, v8
    v_mfma_f32_16x16x32_bf16 v[100:103], v[168:171], v[180:183], v[100:103]
    v_add_u32 v12, s24, v12
    v_mfma_f32_16x16x32_bf16 v[104:107], v[168:171], v[184:187], v[104:107]
    s_mov_b32 s23, s24
    s_add_u32 s25, s25, 1
    v_mfma_f32_16x16x32_bf16 v[108:111], v[168:171], v[188:191], v[108:111]
    s_cmp_eq_u32 s25, 5
    s_cselect_b32 s26, 5, 0
    v_mfma_f32_16x16x32_bf16 v[112:115], v[172:175], v[176:179], v[112:115]
    s_sub_u32 s25, s25, s26
    s_cmp_eq_u32 s25, 4
    v_mfma_f32_16x16x32_bf16 v[116:119], v[172:175], v[180:183], v[116:119]
    s_cselect_b32 s24, s27, s28
    s_sub_u32 s22, s22, 1
    v_mfma_f32_16x16x32_bf16 v[120:123], v[172:175], v[184:187], v[120:123]
    s_cmp_lt_u32 s22, 2
    v_mfma_f32_16x16x32_bf16 v[124:127], v[172:175], v[188:191], v[124:127]
    s_cbranch_scc1 kx_nobar
    s_barrier
kx_nobar:
    s_cmp_lg_u32 s22, 0
    s_cbranch_scc1 kx_cloop
    s_waitcnt lgkmcnt(0)
    s_cmp_lg_u32 s30, 0
    s_cbranch_scc1 kx_epi2
    s_lshl_b32 s19, s17, 8
    s_add_u32 s19, s19, 131072
    v_lshlrev_b32 v7, 4, v2
    v_add_u32 v7, s19, v7
    s_lshl_b32 s19, s18, 8
    s_add_u32 s19, s19, 132096
    v_lshlrev_b32 v6, 2, v1
    v_add_u32 v6, s19, v6
    v_mov_b32 v5, 133120
    s_barrier
    ds_read_b32 v16, v5
    ds_read_b32 v20, v6 offset:0
    ds_read_b32 v22, v6 offset:64
    ds_read_b32 v24, v6 offset:128
    ds_read_b32 v26, v6 offset:192
    ds_read_b128 v[32:35], v7 offset:0
    ds_read_b128 v[36:39], v7 offset:512
    ds_read_b128 v[40:43], v7 offset:64
    ds_read_b128 v[44:47], v7 offset:576
    ds_read_b128 v[48:51], v7 offset:128
    ds_read_b128 v[52:55], v7 offset:640
    ds_read_b128 v[56:59], v7 offset:192
    ds_read_b128 v[60:63], v7 offset:704
    s_lshl_b32 s19, s87, 5
    s_lshl_b32 s20, s85, 1
    s_add_u32 s19, s19, s20
    s_add_u32 s19, s19, s17
    s_lshl_b32 s19, s19, 14
    s_lshl_b32 s20, s18, 13
    s_add_u32 s19, s19, s20
    s_add_u32 s20, s19, 4096
    s_lshl_b32 s29, s87, 4
    s_add_u32 s29, s29, s85
    s_lshl_b32 s29, s29, 7
    s_lshl_b32 s21, s16, 2
    s_add_u32 s29, s29, s21
    s_add_u32 s29, s29, 12582912
    v_lshlrev_b32 v6, 4, v0
    s_waitcnt lgkmcnt(0)
    v_readfirstlane_b32 s84, v16
    v_pk_fma_f32 v[64:65], v[32:33], v[20:21], v[64:65] op_sel_hi:[1,0,1] neg_lo:[1,0,0] neg_hi:[1,0,0]
    v_pk_fma_f32 v[66:67], v[34:35], v[20:21], v[66:67] op_sel_hi:[1,0,1] neg_lo:[1,0,0] neg_hi:[1,0,0]
    v_pk_mul_f32 v[64:65], v[64:65], v[36:37]
    v_pk_mul_f32 v[66:67], v[66:67], v[38:39]
    v_cvt_pk_bf16_f32 v128, v64, v65
    v_cvt_pk_bf16_f32 v129, v66, v67
    v_pk_fma_f32 v[80:81], v[40:41], v[20:21], v[80:81] op_sel_hi:[1,0,1] neg_lo:[1,0,0] neg_hi:[1,0,0]
    v_pk_fma_f32 v[82:83], v[42:43], v[20:21], v[82:83] op_sel_hi:[1,0,1] neg_lo:[1,0,0] neg_hi:[1,0,0]
    v_pk_mul_f32 v[80:81], v[80:81], v[44:45]
    v_pk_mul_f32 v[82:83], v[82:83], v[46:47]
    v_cvt_pk_bf16_f32 v130, v80, v81
    v_cvt_pk_bf16_f32 v131, v82, v83
    s_nop 1
    v_permlane16_swap_b32 v128, v130
    v_permlane16_swap_b32 v129, v131
    s_nop 0
    buffer_store_dwordx4 v[128:131], v6, s[68:71], s19 offen offset:0 sc1
    v_pk_fma_f32 v[96:97], v[48:49], v[20:21], v[96:97] op_sel_hi:[1,0,1] neg_lo:[1,0,0] neg_hi:[1,0,0]
    v_pk_fma_f32 v[98:99], v[50:51], v[20:21], v[98:99] op_sel_hi:[1,0,1] neg_lo:[1,0,0] neg_hi:[1,0,0]
    v_pk_mul_f32 v[96:97], v[96:97], v[52:53]
    v_pk_mul_f32 v[98:99], v[98:99], v[54:55]
    v_cvt_pk_bf16_f32 v132, v96, v97
    v_cvt_pk_bf16_f32 v133, v98, v99
    v_pk_fma_f32 v[112:113], v[56:57], v[20:21], v[112:113] op_sel_hi:[1,0,1] neg_lo:[1,0,0] neg_hi:[1,0,0]
    v_pk_fma_f32 v[114:115], v[58:59], v[20:21], v[114:115] op_sel_hi:[1,0,1] neg_lo:[1,0,0] neg_hi:[1,0,0]
    v_pk_mul_f32 v[112:113], v[112:113], v[60:61]
    v_pk_mul_f32 v[114:115], v[114:115], v[62:63]
    v_cvt_pk_bf16_f32 v134, v112, v113
    v_cvt_pk_bf16_f32 v135, v114, v115
    s_nop 1
    v_permlane16_swap_b32 v132, v134
    v_permlane16_swap_b32 v133, v135
    s_nop 0
    buffer_store_dwordx4 v[132:135], v6, s[68:71], s19 offen offset:1024 sc1
    v_pk_fma_f32 v[68:69], v[32:33], v[22:23], v[68:69] op_sel_hi:[1,0,1] neg_lo:[1,0,0] neg_hi:[1,0,0]
    v_pk_fma_f32 v[70:71], v[34:35], v[22:23], v[70:71] op_sel_hi:[1,0,1] neg_lo:[1,0,0] neg_hi:[1,0,0]
    v_pk_mul_f32 v[68:69], v[68:69], v[36:37]
    v_pk_mul_f32 v[70:71], v[70:71], v[38:39]
    v_cvt_pk_bf16_f32 v136, v68, v69
    v_cvt_pk_bf16_f32 v137, v70, v71
    v_pk_fma_f32 v[84:85], v[40:41], v[22:23], v[84:85] op_sel_hi:[1,0,1] neg_lo:[1,0,0] neg_hi:[1,0,0]
    v_pk_fma_f32 v[86:87], v[42:43], v[22:23], v[86:87] op_sel_hi:[1,0,1] neg_lo:[1,0,0] neg_hi:[1,0,0]
    v_pk_mul_f32 v[84:85], v[84:85], v[44:45]
    v_pk_mul_f32 v[86:87], v[86:87], v[46:47]
    v_cvt_pk_bf16_f32 v138, v84, v85
    v_cvt_pk_bf16_f32 v139, v86, v87
    s_nop 1
    v_permlane16_swap_b32 v136, v138
    v_permlane16_swap_b32 v137, v139
    s_nop 0
    buffer_store_dwordx4 v[136:139], v6, s[68:71], s19 offen offset:2048 sc1
    v_pk_fma_f32 v[100:101], v[48:49], v[22:23], v[100:101] op_sel_hi:[1,0,1] neg_lo:[1,0,0] neg_hi:[1,0,0]
    v_pk_fma_f32 v[102:103], v[50:51], v[22:23], v[102:103] op_sel_hi:[1,0,1] neg_lo:[1,0,0] neg_hi:[1,0,0]
    v_pk_mul_f32 v[100:101], v[100:101], v[52:53]
    v_pk_mul_f32 v[102:103], v[102:103], v[54:55]
    v_cvt_pk_bf16_f32 v140, v100, v101
    v_cvt_pk_bf16_f32 v141, v102, v103
    v_pk_fma_f32 v[116:117], v[56:57], v[22:23], v[116:117] op_sel_hi:[1,0,1] neg_lo:[1,0,0] neg_hi:[1,0,0]
    v_pk_fma_f32 v[118:119], v[58:59], v[22:23], v[118:119] op_sel_hi:[1,0,1] neg_lo:[1,0,0] neg_hi:[1,0,0]
    v_pk_mul_f32 v[116:117], v[116:117], v[60:61]
    v_pk_mul_f32 v[118:119], v[118:119], v[62:63]
    v_cvt_pk_bf16_f32 v142, v116, v117
    v_cvt_pk_bf16_f32 v143, v118, v119
    s_nop 1
    v_permlane16_swap_b32 v140, v142
    v_permlane16_swap_b32 v141, v143
    s_nop 0
    buffer_store_dwordx4 v[140:143], v6, s[68:71], s19 offen offset:3072 sc1
    v_pk_fma_f32 v[72:73], v[32:33], v[24:25], v[72:73] op_sel_hi:[1,0,1] neg_lo:[1,0,0] neg_hi:[1,0,0]
    v_pk_fma_f32 v[74:75], v[34:35], v[24:25], v[74:75] op_sel_hi:[1,0,1] neg_lo:[1,0,0] neg_hi:[1,0,0]
    v_pk_mul_f32 v[72:73], v[72:73], v[36:37]
    v_pk_mul_f32 v[74:75], v[74:75], v[38:39]
    v_cvt_pk_bf16_f32 v144, v72, v73
    v_cvt_pk_bf16_f32 v145, v74, v75
    v_pk_fma_f32 v[88:89], v[40:41], v[24:25], v[88:89] op_sel_hi:[1,0,1] neg_lo:[1,0,0] neg_hi:[1,0,0]
    v_pk_fma_f32 v[90:91], v[42:43], v[24:25], v[90:91] op_sel_hi:[1,0,1] neg_lo:[1,0,0] neg_hi:[1,0,0]
    v_pk_mul_f32 v[88:89], v[88:89], v[44:45]
    v_pk_mul_f32 v[90:91], v[90:91], v[46:47]
    v_cvt_pk_bf16_f32 v146, v88, v89
    v_cvt_pk_bf16_f32 v147, v90, v91
    s_nop 1
    v_permlane16_swap_b32 v144, v146
    v_permlane16_swap_b32 v145, v147
    s_nop 0
    buffer_store_dwordx4 v[144:147], v6, s[68:71], s20 offen offset:0 sc1
    v_pk_fma_f32 v[104:105], v[48:49], v[24:25], v[104:105] op_sel_hi:[1,0,1] neg_lo:[1,0,0] neg_hi:[1,0,0]
    v_pk_fma_f32 v[106:107], v[50:51], v[24:25], v[106:107] op_sel_hi:[1,0,1] neg_lo:[1,0,0] neg_hi:[1,0,0]
    v_pk_mul_f32 v[104:105], v[104:105], v[52:53]
    v_pk_mul_f32 v[106:107], v[106:107], v[54:55]
    v_cvt_pk_bf16_f32 v148, v104, v105
    v_cvt_pk_bf16_f32 v149, v106, v107
    v_pk_fma_f32 v[120:121], v[56:57], v[24:25], v[120:121] op_sel_hi:[1,0,1] neg_lo:[1,0,0] neg_hi:[1,0,0]
    v_pk_fma_f32 v[122:123], v[58:59], v[24:25], v[122:123] op_sel_hi:[1,0,1] neg_lo:[1,0,0] neg_hi:[1,0,0]
    v_pk_mul_f32 v[120:121], v[120:121], v[60:61]
    v_pk_mul_f32 v[122:123], v[122:123], v[62:63]
    v_cvt_pk_bf16_f32 v150, v120, v121
    v_cvt_pk_bf16_f32 v151, v122, v123
    s_nop 1
    v_permlane16_swap_b32 v148, v150
    v_permlane16_swap_b32 v149, v151
    s_nop 0
    buffer_store_dwordx4 v[148:151], v6, s[68:71], s20 offen offset:1024 sc1
    v_pk_fma_f32 v[76:77], v[32:33], v[26:27], v[76:77] op_sel_hi:[1,0,1] neg_lo:[1,0,0] neg_hi:[1,0,0]
    v_pk_fma_f32 v[78:79], v[34:35], v[26:27], v[78:79] op_sel_hi:[1,0,1] neg_lo:[1,0,0] neg_hi:[1,0,0]
    v_pk_mul_f32 v[76:77], v[76:77], v[36:37]
    v_pk_mul_f32 v[78:79], v[78:79], v[38:39]
    v_cvt_pk_bf16_f32 v152, v76, v77
    v_cvt_pk_bf16_f32 v153, v78, v79
    v_pk_fma_f32 v[92:93], v[40:41], v[26:27], v[92:93] op_sel_hi:[1,0,1] neg_lo:[1,0,0] neg_hi:[1,0,0]
    v_pk_fma_f32 v[94:95], v[42:43], v[26:27], v[94:95] op_sel_hi:[1,0,1] neg_lo:[1,0,0] neg_hi:[1,0,0]
    v_pk_mul_f32 v[92:93], v[92:93], v[44:45]
    v_pk_mul_f32 v[94:95], v[94:95], v[46:47]
    v_cvt_pk_bf16_f32 v154, v92, v93
    v_cvt_pk_bf16_f32 v155, v94, v95
    s_nop 1
    v_permlane16_swap_b32 v152, v154
    v_permlane16_swap_b32 v153, v155
    s_nop 0
    buffer_store_dwordx4 v[152:155], v6, s[68:71], s20 offen offset:2048 sc1
    v_pk_fma_f32 v[108:109], v[48:49], v[26:27], v[108:109] op_sel_hi:[1,0,1] neg_lo:[1,0,0] neg_hi:[1,0,0]
    v_pk_fma_f32 v[110:111], v[50:51], v[26:27], v[110:111] op_sel_hi:[1,0,1] neg_lo:[1,0,0] neg_hi:[1,0,0]
    v_pk_mul_f32 v[108:109], v[108:109], v[52:53]
    v_pk_mul_f32 v[110:111], v[110:111], v[54:55]
    v_cvt_pk_bf16_f32 v156, v108, v109
    v_cvt_pk_bf16_f32 v157, v110, v111
    v_pk_fma_f32 v[124:125], v[56:57], v[26:27], v[124:125] op_sel_hi:[1,0,1] neg_lo:[1,0,0] neg_hi:[1,0,0]
    v_pk_fma_f32 v[126:127], v[58:59], v[26:27], v[126:127] op_sel_hi:[1,0,1] neg_lo:[1,0,0] neg_hi:[1,0,0]
    v_pk_mul_f32 v[124:125], v[124:125], v[60:61]
    v_pk_mul_f32 v[126:127], v[126:127], v[62:63]
    v_cvt_pk_bf16_f32 v158, v124, v125
    v_cvt_pk_bf16_f32 v159, v126, v127
    s_nop 1
    v_permlane16_swap_b32 v156, v158
    v_permlane16_swap_b32 v157, v159
    s_nop 0
    buffer_store_dwordx4 v[156:159], v6, s[68:71], s20 offen offset:3072 sc1
    v_mov_b32 v4, 0
    v_mov_b32 v5, s84
    s_barrier
    s_waitcnt vmcnt(0)
    s_mov_b64 exec, 1
    buffer_store_dword v5, v4, s[68:71], s29 offen sc1
    s_mov_b64 exec, -1
    s_lshl_b32 s31, s16, 6
    v_add_u32 v199, s31, v0
    v_mov_b32 v16, -1
    v_mov_b32 v17, -1
    v_mov_b32 v18, -1
    v_mov_b32 v19, -1
    v_lshlrev_b32 v4, 4, v0
    s_and_b32 s21, s16, 1
    s_lshl_b32 s21, s21, 10
    s_cmp_lt_u32 s16, 2
    s_cbranch_scc1 kx_c2ag
    s_lshl_b32 s20, s64, 11
    s_add_u32 s20, s20, s21
    s_add_u32 s20, s20, 16777216
    buffer_store_dwordx4 v[16:19], v4, s[68:71], s20 offen sc1
kx_c2ag:
    s_cmp_ge_u32 s65, 28
    s_cbranch_scc1 kx_c2finalg
    s_and_b32 s66, s59, 7
    s_lshl_b32 s26, s65, 3
    s_add_u32 s66, s66, s26
    s_cmp_ge_u32 s16, 2
    s_cbranch_scc1 kx_c2bg
    s_lshl_b32 s20, s66, 11
    s_add_u32 s20, s20, s21
    s_add_u32 s20, s20, 15728640
    buffer_store_dwordx4 v[16:19], v4, s[68:71], s20 offen sc1
kx_c2bg:
    s_branch kx_c2doneg
kx_c2finalg:
    s_sub_u32 s66, s58, 4
    s_lshl_b32 s66, s66, 3
    s_add_u32 s66, s66, s59
    s_sub_u32 s66, s66, 24
    s_lshl_b32 s66, s66, 1
    s_add_u32 s66, s66, s16
kx_c2doneg:
    s_branch kx_cons2
kx_epi2:
    s_lshl_b32 s19, s64, 15
    s_lshl_b32 s20, s16, 13
    s_add_u32 s19, s19, s20
    s_add_u32 s19, s19, 4194304
    s_add_u32 s20, s19, 4096
    s_lshl_b32 s29, s64, 7
    s_lshl_b32 s21, s16, 2
    s_add_u32 s29, s29, s21
    s_add_u32 s29, s29, 12599296
    v_lshlrev_b32 v6, 4, v0
    v_cvt_pk_bf16_f32 v128, v64, v65
    v_cvt_pk_bf16_f32 v129, v66, v67
    v_cvt_pk_bf16_f32 v130, v80, v81
    v_cvt_pk_bf16_f32 v131, v82, v83
    s_nop 1
    v_permlane16_swap_b32 v128, v130
    v_permlane16_swap_b32 v129, v131
    s_nop 0
    buffer_store_dwordx4 v[128:131], v6, s[68:71], s19 offen offset:0 sc1
    v_cvt_pk_bf16_f32 v132, v96, v97
    v_cvt_pk_bf16_f32 v133, v98, v99
    v_cvt_pk_bf16_f32 v134, v112, v113
    v_cvt_pk_bf16_f32 v135, v114, v115
    s_nop 1
    v_permlane16_swap_b32 v132, v134
    v_permlane16_swap_b32 v133, v135
    s_nop 0
    buffer_store_dwordx4 v[132:135], v6, s[68:71], s19 offen offset:1024 sc1
    v_cvt_pk_bf16_f32 v136, v68, v69
    v_cvt_pk_bf16_f32 v137, v70, v71
    v_cvt_pk_bf16_f32 v138, v84, v85
    v_cvt_pk_bf16_f32 v139, v86, v87
    s_nop 1
    v_permlane16_swap_b32 v136, v138
    v_permlane16_swap_b32 v137, v139
    s_nop 0
    buffer_store_dwordx4 v[136:139], v6, s[68:71], s19 offen offset:2048 sc1
    v_cvt_pk_bf16_f32 v140, v100, v101
    v_cvt_pk_bf16_f32 v141, v102, v103
    v_cvt_pk_bf16_f32 v142, v116, v117
    v_cvt_pk_bf16_f32 v143, v118, v119
    s_nop 1
    v_permlane16_swap_b32 v140, v142
    v_permlane16_swap_b32 v141, v143
    s_nop 0
    buffer_store_dwordx4 v[140:143], v6, s[68:71], s19 offen offset:3072 sc1
    v_cvt_pk_bf16_f32 v144, v72, v73
    v_cvt_pk_bf16_f32 v145, v74, v75
    v_cvt_pk_bf16_f32 v146, v88, v89
    v_cvt_pk_bf16_f32 v147, v90, v91
    s_nop 1
    v_permlane16_swap_b32 v144, v146
    v_permlane16_swap_b32 v145, v147
    s_nop 0
    buffer_store_dwordx4 v[144:147], v6, s[68:71], s20 offen offset:0 sc1
    v_cvt_pk_bf16_f32 v148, v104, v105
    v_cvt_pk_bf16_f32 v149, v106, v107
    v_cvt_pk_bf16_f32 v150, v120, v121
    v_cvt_pk_bf16_f32 v151, v122, v123
    s_nop 1
    v_permlane16_swap_b32 v148, v150
    v_permlane16_swap_b32 v149, v151
    s_nop 0
    buffer_store_dwordx4 v[148:151], v6, s[68:71], s20 offen offset:1024 sc1
    v_cvt_pk_bf16_f32 v152, v76, v77
    v_cvt_pk_bf16_f32 v153, v78, v79
    v_cvt_pk_bf16_f32 v154, v92, v93
    v_cvt_pk_bf16_f32 v155, v94, v95
    s_nop 1
    v_permlane16_swap_b32 v152, v154
    v_permlane16_swap_b32 v153, v155
    s_nop 0
    buffer_store_dwordx4 v[152:155], v6, s[68:71], s20 offen offset:2048 sc1
    v_cvt_pk_bf16_f32 v156, v108, v109
    v_cvt_pk_bf16_f32 v157, v110, v111
    v_cvt_pk_bf16_f32 v158, v124, v125
    v_cvt_pk_bf16_f32 v159, v126, v127
    s_nop 1
    v_permlane16_swap_b32 v156, v158
    v_permlane16_swap_b32 v157, v159
    s_nop 0
    buffer_store_dwordx4 v[156:159], v6, s[68:71], s20 offen offset:3072 sc1
    v_mov_b32 v4, 0
    v_mov_b32 v5, s84
    s_waitcnt vmcnt(0)
    s_mov_b64 exec, 1
    buffer_store_dword v5, v4, s[68:71], s29 offen sc1
    s_mov_b64 exec, -1
    s_branch kx_rows
kx_cons2:
    s_mov_b32 s30, 1
    s_mov_b32 s22, 16
    s_barrier
    s_branch kx_cons
kx_loader1:
    s_lshl_b32 s19, s85, 17
    s_add_u32 s22, s32, s19
    s_addc_u32 s23, s33, 0
    s_mov_b32 s4, s22
    s_and_b32 s5, s23, 0xffff
    s_mov_b32 s6, 131072
    s_mov_b32 s7, 0x00020000
    s_cmp_eq_u32 s89, 0
    s_cselect_b32 s22, s38, s40
    s_cselect_b32 s23, s39, s41
    s_lshl_b32 s19, s86, 17
    s_add_u32 s22, s22, s19
    s_addc_u32 s23, s23, 0
    s_mov_b32 s8, s22
    s_and_b32 s9, s23, 0xffff
    s_mov_b32 s10, 131072
    s_mov_b32 s11, 0x00020000
    s_sub_u32 s17, s16, 4
    v_lshrrev_b32 v6, 3, v0
    v_lshrrev_b32 v7, 4, v0
    v_and_b32 v16, 7, v0
    s_lshl_b32 s18, s17, 5
    v_add_u32 v18, 0, v7
    v_and_b32 v18, 7, v18
    v_xor_b32 v18, v18, v16
    v_lshlrev_b32 v18, 4, v18
    v_add3_u32 v17, v6, s18, 0
    v_lshlrev_b32 v17, 10, v17
    v_add_u32 v17, v17, v18
    v_subrev_u32 v8, 0, v17
    v_add_u32 v18, 4, v7
    v_and_b32 v18, 7, v18
    v_xor_b32 v18, v18, v16
    v_lshlrev_b32 v18, 4, v18
    v_add3_u32 v17, v6, s18, 8
    v_lshlrev_b32 v17, 10, v17
    v_add_u32 v17, v17, v18
    v_subrev_u32 v9, 1024, v17
    v_add_u32 v18, 8, v7
    v_and_b32 v18, 7, v18
    v_xor_b32 v18, v18, v16
    v_lshlrev_b32 v18, 4, v18
    v_add3_u32 v17, v6, s18, 16
    v_lshlrev_b32 v17, 10, v17
    v_add_u32 v17, v17, v18
    v_subrev_u32 v10, 2048, v17
    v_add_u32 v18, 12, v7
    v_and_b32 v18, 7, v18
    v_xor_b32 v18, v18, v16
    v_lshlrev_b32 v18, 4, v18
    v_add3_u32 v17, v6, s18, 24
    v_lshlrev_b32 v17, 10, v17
    v_add_u32 v17, v17, v18
    v_subrev_u32 v11, 3072, v17
    s_lshl_b32 s21, s17, 12
    s_mov_b32 s20, 0
    s_mov_b32 s22, 0
kx_l1loop:
    s_mov_b32 m0, s21
    s_add_u32 s19, s21, 16384
    buffer_load_dwordx4 v8, s[4:7], s20 offen offset:0 lds
    buffer_load_dwordx4 v9, s[4:7], s20 offen offset:1024 lds
    buffer_load_dwordx4 v10, s[4:7], s20 offen offset:2048 lds
    buffer_load_dwordx4 v11, s[4:7], s20 offen offset:3072 lds
    s_mov_b32 m0, s19
    s_add_u32 s22, s22, 1
    buffer_load_dwordx4 v8, s[8:11], s20 offen offset:0 lds
    buffer_load_dwordx4 v9, s[8:11], s20 offen offset:1024 lds
    buffer_load_dwordx4 v10, s[8:11], s20 offen offset:2048 lds
    buffer_load_dwordx4 v11, s[8:11], s20 offen offset:3072 lds
    s_add_u32 s20, s20, 128
    s_add_u32 s21, s21, 32768
    s_cmp_eq_u32 s22, 5
    s_cselect_b32 s19, 163840, 0
    s_sub_u32 s21, s21, s19
    s_cmp_lt_u32 s22, 4
    s_cbranch_scc1 kx_l1loop
    s_waitcnt vmcnt(16)
    s_barrier
    s_cmp_lt_u32 s22, 8
    s_cbranch_scc1 kx_l1loop
    s_lshl_b32 s19, s3, 7
    s_lshl_b32 s24, s86, 7
    s_add_u32 s24, s24, 480
    v_mov_b32 v20, s19
    v_mov_b32 v21, s24
    v_cmp_gt_u32 vcc, 32, v0
    v_add_u32 v22, s18, v0
    v_cndmask_b32 v20, v21, v20, vcc
    v_add_lshl_u32 v20, v20, v22, 3
    s_lshl_b32 s24, s58, 13
    s_add_u32 s24, s24, 13631488
    buffer_load_dword v194, v197, s[72:75], 0 offen sc1
    buffer_load_dwordx2 v[24:25], v20, s[68:71], s24 offen sc1
    s_waitcnt vmcnt(10)
    s_barrier
    s_waitcnt vmcnt(2)
    s_barrier
    v_lshlrev_b32 v22, 2, v22
    v_add_u32 v22, 131072, v22
    s_waitcnt vmcnt(0)
    v_cmp_ne_u32 vcc, v25, v194
    v_cmp_eq_u32 s[26:27], 0, v194
    s_nop 2
    s_or_b64 vcc, vcc, s[26:27]
    s_cmp_eq_u64 vcc, 0
    s_cbranch_scc1 kx_polln_done
    s_mov_b32 s31, 0
kx_polln:
    buffer_load_dword v194, v197, s[72:75], 0 offen sc1
    buffer_load_dwordx2 v[24:25], v20, s[68:71], s24 offen sc1
    s_waitcnt vmcnt(0)
    v_cmp_ne_u32 vcc, v25, v194
    v_cmp_eq_u32 s[26:27], 0, v194
    s_nop 2
    s_or_b64 vcc, vcc, s[26:27]
    s_add_u32 s31, s31, 1
    s_nop 1
    s_cmp_eq_u64 vcc, 0
    s_cbranch_scc1 kx_polln_done
    s_cmp_ge_u32 s31, 1048576
    s_cbranch_scc1 kx_polln_done
    s_sleep 4
    s_branch kx_polln
kx_polln_done:
    v_readfirstlane_b32 s84, v194
    v_lshlrev_b32 v26, 16, v24
    v_rcp_f32 v26, v26
    v_and_b32 v27, 0xffff0000, v24
    v_mov_b32 v195, 133120
    s_mov_b32 exec_hi, 0
    ds_write_b32 v22, v27 offset:0
    ds_write_b32 v22, v26 offset:512
    s_not_b64 exec, exec
    ds_write_b32 v22, v24 offset:896
    s_mov_b64 exec, -1
    ds_write_b32 v195, v194
    s_waitcnt lgkmcnt(0)
    s_barrier
    s_branch kx_loader2
kx_pref:
    v_lshrrev_b32 v6, 3, v0
    v_and_b32 v7, 7, v0
    v_lshlrev_b32 v8, 12, v6
    v_lshlrev_b32 v6, 10, v6
    v_lshlrev_b32 v9, 7, v7
    v_add_u32 v6, v6, v9
    v_add_u32 v14, v8, v9
    s_cmp_eq_u32 s89, 0
    s_cselect_b32 s24, s38, s40
    s_cselect_b32 s25, s39, s41
    s_cselect_b32 s26, s34, s36
    s_cselect_b32 s27, s35, s37
    s_lshl_b32 s19, s85, 17
    s_add_u32 s22, s32, s19
    s_addc_u32 s23, s33, 0
    s_cmp_lt_u32 s86, 8
    s_cselect_b32 s22, s22, s24
    s_cselect_b32 s23, s23, s25
    s_mov_b32 s4, s22
    s_and_b32 s5, s23, 0xffff
    s_mov_b32 s6, 524288
    s_mov_b32 s7, 0x00020000
    s_and_b32 s19, s86, 7
    s_lshl_b32 s19, s19, 16
    s_lshl_b32 s20, s16, 13
    s_add_u32 s19, s19, s20
    v_lshlrev_b32 v11, 4, v0
    s_add_u32 s29, s19, 4096
    buffer_load_dwordx4 v[64:67], v11, s[4:7], s19 offen offset:0
    buffer_load_dwordx4 v[68:71], v11, s[4:7], s19 offen offset:1024
    buffer_load_dwordx4 v[72:75], v11, s[4:7], s19 offen offset:2048
    buffer_load_dwordx4 v[76:79], v11, s[4:7], s19 offen offset:3072
    buffer_load_dwordx4 v[80:83], v11, s[4:7], s29 offen offset:0
    buffer_load_dwordx4 v[84:87], v11, s[4:7], s29 offen offset:1024
    buffer_load_dwordx4 v[88:91], v11, s[4:7], s29 offen offset:2048
    buffer_load_dwordx4 v[92:95], v11, s[4:7], s29 offen offset:3072
    s_lshl_b32 s19, s60, 22
    s_lshl_b32 s20, s86, 18
    s_add_u32 s19, s19, s20
    s_lshl_b32 s20, s88, 11
    s_add_u32 s19, s19, s20
    s_lshl_b32 s20, s16, 15
    s_add_u32 s19, s19, s20
    s_add_u32 s26, s26, s19
    s_addc_u32 s27, s27, 0
    s_mov_b32 s8, s26
    s_and_b32 s9, s27, 0xffff
    s_mov_b32 s10, 30720
    s_mov_b32 s11, 0x00020000
    v_cmp_gt_u32 vcc, 0, v7
    v_mov_b32 v15, 0x40000000
    v_cndmask_b32 v15, v15, v14, vcc
    s_lshl_b32 s19, s86, 3
    s_add_u32 s19, s19, s16
    s_mul_i32 s20, s19, 2731
    s_lshr_b32 s20, s20, 16
    s_mul_i32 s21, s20, 24
    s_sub_u32 s21, s19, s21
    s_lshl_b32 s20, s20, 3
    s_add_u32 s20, s20, s58
    s_movk_i32 s19, 3584
    v_mul_lo_u32 v10, v0, s19
    s_mov_b32 s31, 0
kx_pollp:
    buffer_load_dword v194, v197, s[72:75], 0 offen sc1
    s_waitcnt vmcnt(0)
    v_cmp_eq_u32 vcc, 0, v194
    s_add_u32 s31, s31, 1
    s_nop 1
    s_cmp_eq_u64 vcc, 0
    s_cbranch_scc1 kx_pollp_done
    s_cmp_ge_u32 s31, 1048576
    s_cbranch_scc1 kx_pollp_done
    s_sleep 4
    s_branch kx_pollp
kx_pollp_done:
    v_readfirstlane_b32 s84, v194
    v_lshlrev_b32 v16, 16, v64
    v_and_b32 v17, 0xffff0000, v64
    v_lshlrev_b32 v18, 16, v65
    v_and_b32 v19, 0xffff0000, v65
    v_lshlrev_b32 v20, 16, v66
    v_and_b32 v21, 0xffff0000, v66
    v_lshlrev_b32 v22, 16, v67
    v_and_b32 v23, 0xffff0000, v67
    v_pk_add_f32 v[24:25], v[16:17], v[18:19]
    v_pk_mul_f32 v[28:29], v[16:17], v[16:17]
    v_pk_add_f32 v[26:27], v[20:21], v[22:23]
    v_pk_fma_f32 v[28:29], v[18:19], v[18:19], v[28:29]
    v_pk_add_f32 v[24:25], v[24:25], v[26:27]
    v_pk_fma_f32 v[28:29], v[20:21], v[20:21], v[28:29]
    v_add_f32 v32, v24, v25
    v_pk_fma_f32 v[28:29], v[22:23], v[22:23], v[28:29]
    v_add_f32 v40, v28, v29
    v_lshlrev_b32 v16, 16, v68
    v_and_b32 v17, 0xffff0000, v68
    v_lshlrev_b32 v18, 16, v69
    v_and_b32 v19, 0xffff0000, v69
    v_lshlrev_b32 v20, 16, v70
    v_and_b32 v21, 0xffff0000, v70
    v_lshlrev_b32 v22, 16, v71
    v_and_b32 v23, 0xffff0000, v71
    v_pk_add_f32 v[24:25], v[16:17], v[18:19]
    v_pk_mul_f32 v[28:29], v[16:17], v[16:17]
    v_pk_add_f32 v[26:27], v[20:21], v[22:23]
    v_pk_fma_f32 v[28:29], v[18:19], v[18:19], v[28:29]
    v_pk_add_f32 v[24:25], v[24:25], v[26:27]
    v_pk_fma_f32 v[28:29], v[20:21], v[20:21], v[28:29]
    v_add_f32 v33, v24, v25
    v_pk_fma_f32 v[28:29], v[22:23], v[22:23], v[28:29]
    v_add_f32 v41, v28, v29
    v_lshlrev_b32 v16, 16, v72
    v_and_b32 v17, 0xffff0000, v72
    v_lshlrev_b32 v18, 16, v73
    v_and_b32 v19, 0xffff0000, v73
    v_lshlrev_b32 v20, 16, v74
    v_and_b32 v21, 0xffff0000, v74
    v_lshlrev_b32 v22, 16, v75
    v_and_b32 v23, 0xffff0000, v75
    v_pk_add_f32 v[24:25], v[16:17], v[18:19]
    v_pk_mul_f32 v[28:29], v[16:17], v[16:17]
    v_pk_add_f32 v[26:27], v[20:21], v[22:23]
    v_pk_fma_f32 v[28:29], v[18:19], v[18:19], v[28:29]
    v_pk_add_f32 v[24:25], v[24:25], v[26:27]
    v_pk_fma_f32 v[28:29], v[20:21], v[20:21], v[28:29]
    v_add_f32 v34, v24, v25
    v_pk_fma_f32 v[28:29], v[22:23], v[22:23], v[28:29]
    v_add_f32 v42, v28, v29
    v_lshlrev_b32 v16, 16, v76
    v_and_b32 v17, 0xffff0000, v76
    v_lshlrev_b32 v18, 16, v77
    v_and_b32 v19, 0xffff0000, v77
    v_lshlrev_b32 v20, 16, v78
    v_and_b32 v21, 0xffff0000, v78
    v_lshlrev_b32 v22, 16, v79
    v_and_b32 v23, 0xffff0000, v79
    v_pk_add_f32 v[24:25], v[16:17], v[18:19]
    v_pk_mul_f32 v[28:29], v[16:17], v[16:17]
    v_pk_add_f32 v[26:27], v[20:21], v[22:23]
    v_pk_fma_f32 v[28:29], v[18:19], v[18:19], v[28:29]
    v_pk_add_f32 v[24:25], v[24:25], v[26:27]
    v_pk_fma_f32 v[28:29], v[20:21], v[20:21], v[28:29]
    v_add_f32 v35, v24, v25
    v_pk_fma_f32 v[28:29], v[22:23], v[22:23], v[28:29]
    v_add_f32 v43, v28, v29
    v_lshlrev_b32 v16, 16, v80
    v_and_b32 v17, 0xffff0000, v80
    v_lshlrev_b32 v18, 16, v81
    v_and_b32 v19, 0xffff0000, v81
    v_lshlrev_b32 v20, 16, v82
    v_and_b32 v21, 0xffff0000, v82
    v_lshlrev_b32 v22, 16, v83
    v_and_b32 v23, 0xffff0000, v83
    v_pk_add_f32 v[24:25], v[16:17], v[18:19]
    v_pk_mul_f32 v[28:29], v[16:17], v[16:17]
    v_pk_add_f32 v[26:27], v[20:21], v[22:23]
    v_pk_fma_f32 v[28:29], v[18:19], v[18:19], v[28:29]
    v_pk_add_f32 v[24:25], v[24:25], v[26:27]
    v_pk_fma_f32 v[28:29], v[20:21], v[20:21], v[28:29]
    v_add_f32 v36, v24, v25
    v_pk_fma_f32 v[28:29], v[22:23], v[22:23], v[28:29]
    v_add_f32 v44, v28, v29
    v_lshlrev_b32 v16, 16, v84
    v_and_b32 v17, 0xffff0000, v84
    v_lshlrev_b32 v18, 16, v85
    v_and_b32 v19, 0xffff0000, v85
    v_lshlrev_b32 v20, 16, v86
    v_and_b32 v21, 0xffff0000, v86
    v_lshlrev_b32 v22, 16, v87
    v_and_b32 v23, 0xffff0000, v87
    v_pk_add_f32 v[24:25], v[16:17], v[18:19]
    v_pk_mul_f32 v[28:29], v[16:17], v[16:17]
    v_pk_add_f32 v[26:27], v[20:21], v[22:23]
    v_pk_fma_f32 v[28:29], v[18:19], v[18:19], v[28:29]
    v_pk_add_f32 v[24:25], v[24:25], v[26:27]
    v_pk_fma_f32 v[28:29], v[20:21], v[20:21], v[28:29]
    v_add_f32 v37, v24, v25
    v_pk_fma_f32 v[28:29], v[22:23], v[22:23], v[28:29]
    v_add_f32 v45, v28, v29
    v_lshlrev_b32 v16, 16, v88
    v_and_b32 v17, 0xffff0000, v88
    v_lshlrev_b32 v18, 16, v89
    v_and_b32 v19, 0xffff0000, v89
    v_lshlrev_b32 v20, 16, v90
    v_and_b32 v21, 0xffff0000, v90
    v_lshlrev_b32 v22, 16, v91
    v_and_b32 v23, 0xffff0000, v91
    v_pk_add_f32 v[24:25], v[16:17], v[18:19]
    v_pk_mul_f32 v[28:29], v[16:17], v[16:17]
    v_pk_add_f32 v[26:27], v[20:21], v[22:23]
    v_pk_fma_f32 v[28:29], v[18:19], v[18:19], v[28:29]
    v_pk_add_f32 v[24:25], v[24:25], v[26:27]
    v_pk_fma_f32 v[28:29], v[20:21], v[20:21], v[28:29]
    v_add_f32 v38, v24, v25
    v_pk_fma_f32 v[28:29], v[22:23], v[22:23], v[28:29]
    v_add_f32 v46, v28, v29
    v_lshlrev_b32 v16, 16, v92
    v_and_b32 v17, 0xffff0000, v92
    v_lshlrev_b32 v18, 16, v93
    v_and_b32 v19, 0xffff0000, v93
    v_lshlrev_b32 v20, 16, v94
    v_and_b32 v21, 0xffff0000, v94
    v_lshlrev_b32 v22, 16, v95
    v_and_b32 v23, 0xffff0000, v95
    v_pk_add_f32 v[24:25], v[16:17], v[18:19]
    v_pk_mul_f32 v[28:29], v[16:17], v[16:17]
    v_pk_add_f32 v[26:27], v[20:21], v[22:23]
    v_pk_fma_f32 v[28:29], v[18:19], v[18:19], v[28:29]
    v_pk_add_f32 v[24:25], v[24:25], v[26:27]
    v_pk_fma_f32 v[28:29], v[20:21], v[20:21], v[28:29]
    v_add_f32 v39, v24, v25
    v_pk_fma_f32 v[28:29], v[22:23], v[22:23], v[28:29]
    v_add_f32 v47, v28, v29
    s_nop 1
    v_permlane32_swap_b32 v32, v40
    v_permlane32_swap_b32 v33, v41
    v_permlane32_swap_b32 v34, v42
    v_permlane32_swap_b32 v35, v43
    v_permlane32_swap_b32 v36, v44
    v_permlane32_swap_b32 v37, v45
    v_permlane32_swap_b32 v38, v46
    v_permlane32_swap_b32 v39, v47
    s_nop 1
    v_add_f32 v32, v32, v40
    v_add_f32 v33, v33, v41
    v_add_f32 v34, v34, v42
    v_add_f32 v35, v35, v43
    v_add_f32 v36, v36, v44
    v_add_f32 v37, v37, v45
    v_add_f32 v38, v38, v46
    v_add_f32 v39, v39, v47
    s_nop 1
    v_permlane16_swap_b32 v32, v36
    v_permlane16_swap_b32 v33, v37
    v_permlane16_swap_b32 v34, v38
    v_permlane16_swap_b32 v35, v39
    s_nop 1
    v_add_f32 v32, v32, v36
    v_add_f32 v33, v33, v37
    v_add_f32 v34, v34, v38
    v_add_f32 v35, v35, v39
    s_nop 0
    v_add_f32_dpp v32, v32, v32 row_ror:8 row_mask:0xf bank_mask:0xf
    v_add_f32_dpp v33, v33, v33 row_ror:8 row_mask:0xf bank_mask:0xf
    v_add_f32_dpp v34, v34, v34 row_ror:8 row_mask:0xf bank_mask:0xf
    v_add_f32_dpp v35, v35, v35 row_ror:8 row_mask:0xf bank_mask:0xf
    s_nop 0
    v_add_f32_dpp v32, v32, v32 row_ror:4 row_mask:0xf bank_mask:0xf
    v_add_f32_dpp v33, v33, v33 row_ror:4 row_mask:0xf bank_mask:0xf
    v_add_f32_dpp v34, v34, v34 row_ror:4 row_mask:0xf bank_mask:0xf
    v_add_f32_dpp v35, v35, v35 row_ror:4 row_mask:0xf bank_mask:0xf
    s_nop 0
    v_add_f32_dpp v32, v32, v32 row_ror:2 row_mask:0xf bank_mask:0xf
    v_add_f32_dpp v33, v33, v33 row_ror:2 row_mask:0xf bank_mask:0xf
    v_add_f32_dpp v34, v34, v34 row_ror:2 row_mask:0xf bank_mask:0xf
    v_add_f32_dpp v35, v35, v35 row_ror:2 row_mask:0xf bank_mask:0xf
    s_nop 0
    v_add_f32_dpp v32, v32, v32 row_ror:1 row_mask:0xf bank_mask:0xf
    v_add_f32_dpp v33, v33, v33 row_ror:1 row_mask:0xf bank_mask:0xf
    v_add_f32_dpp v34, v34, v34 row_ror:1 row_mask:0xf bank_mask:0xf
    v_add_f32_dpp v35, v35, v35 row_ror:1 row_mask:0xf bank_mask:0xf
    v_and_b32 v16, 3, v0
    v_cmp_eq_u32 s[22:23], 1, v16
    v_cmp_eq_u32 s[24:25], 2, v16
    v_cmp_eq_u32 s[26:27], 3, v16
    v_lshrrev_b32 v17, 4, v0
    v_cndmask_b32 v32, v32, v33, s[22:23]
    v_cndmask_b32 v32, v32, v34, s[24:25]
    v_cndmask_b32 v32, v32, v35, s[26:27]
    v_mov_b32 v33, v32
    v_lshl_add_u32 v16, v17, 2, v16
    s_nop 0
    v_permlane32_swap_b32 v32, v33
    s_lshl_b32 s22, s86, 6
    s_lshl_b32 s23, s16, 3
    s_add_u32 s22, s22, s23
    v_add_lshl_u32 v16, v16, s22, 3
    v_mul_f32 v28, 0x3b000000, v32
    v_mul_f32 v29, 0x3b000000, v33
    v_fma_f32 v29, -v28, v28, v29
    v_max_f32 v29, 0, v29
    v_cvt_pk_bf16_f32 v30, v28, v28
    v_and_b32 v30, 0xffff0000, v30
    v_cvt_pk_bf16_f32 v29, v29, v29
    v_and_b32 v29, 0xffff0000, v29
    v_add_f32 v29, 0x3727c5ac, v29
    v_cvt_pk_bf16_f32 v29, v29, v29
    v_and_b32 v29, 0xffff0000, v29
    v_sqrt_f32 v29, v29
    s_lshl_b32 s22, s58, 13
    v_cvt_pk_bf16_f32 v29, v29, v29
    v_and_b32 v29, 0xffff, v29
    v_or_b32 v30, v30, v29
    s_add_u32 s22, s22, 13631488
    s_cmp_lt_u32 s86, 8
    s_cbranch_scc1 kx_pf_x
    v_mov_b32 v30, v32
kx_pf_x:
    v_mov_b32 v31, s84
    s_mov_b64 exec, 0x000f000f
    buffer_store_dwordx2 v[30:31], v16, s[68:71], s22 offen sc1
    s_mov_b64 exec, -1
    s_cmp_ge_u32 s20, 28
    s_cbranch_scc1 kx_pf_done
    s_cmp_ge_u32 s21, 16
    s_cbranch_scc1 kx_pf_wd
    s_cmp_lt_u32 s21, 8
    s_cselect_b32 s22, s46, s48
    s_cselect_b32 s23, s47, s49
    s_mov_b32 s12, s22
    s_and_b32 s13, s23, 0xffff
    s_mov_b32 s14, 1835008
    s_mov_b32 s15, 0x00020000
    s_and_b32 s21, s21, 7
    s_mul_i32 s19, s21, 229376
    s_lshl_b32 s20, s20, 7
    s_add_u32 s19, s19, s20
    buffer_load_dword v61, v10, s[12:15], s19 offen
    s_branch kx_pf_done
kx_pf_wd:
    s_mov_b32 s12, s50
    s_and_b32 s13, s51, 0xffff
    s_mov_b32 s14, 1835008
    s_mov_b32 s15, 0x00020000
    s_sub_u32 s21, s21, 16
    s_lshl_b32 s19, s20, 16
    s_lshl_b32 s21, s21, 13
    s_add_u32 s19, s19, s21
    buffer_load_dword v61, v6, s[12:15], s19 offen
kx_pf_done:
    buffer_load_dword v62, v14, s[8:11], 0 offen offset:512
    s_waitcnt vmcnt(0)
    s_cmp_ge_u32 s16, 4
    s_cbranch_scc1 kx_loader2
    s_lshl_b32 s31, s16, 6
    v_add_u32 v199, s31, v0
    v_mov_b32 v16, -1
    v_mov_b32 v17, -1
    v_mov_b32 v18, -1
    v_mov_b32 v19, -1
    v_lshlrev_b32 v4, 4, v0
    s_and_b32 s21, s16, 1
    s_lshl_b32 s21, s21, 10
    s_cmp_lt_u32 s16, 2
    s_cbranch_scc1 kx_c2ap
    s_lshl_b32 s20, s64, 11
    s_add_u32 s20, s20, s21
    s_add_u32 s20, s20, 16777216
    buffer_store_dwordx4 v[16:19], v4, s[68:71], s20 offen sc1
kx_c2ap:
    s_cmp_ge_u32 s65, 28
    s_cbranch_scc1 kx_c2finalp
    s_and_b32 s66, s59, 7
    s_lshl_b32 s26, s65, 3
    s_add_u32 s66, s66, s26
    s_cmp_ge_u32 s16, 2
    s_cbranch_scc1 kx_c2bp
    s_lshl_b32 s20, s66, 11
    s_add_u32 s20, s20, s21
    s_add_u32 s20, s20, 15728640
    buffer_store_dwordx4 v[16:19], v4, s[68:71], s20 offen sc1
kx_c2bp:
    s_branch kx_c2donep
kx_c2finalp:
    s_sub_u32 s66, s58, 4
    s_lshl_b32 s66, s66, 3
    s_add_u32 s66, s66, s59
    s_sub_u32 s66, s66, 24
    s_lshl_b32 s66, s66, 1
    s_add_u32 s66, s66, s16
kx_c2donep:
    s_barrier
    s_branch kx_cons2
kx_loader2:
    s_lshl_b32 s19, s89, 2
    s_add_u32 s19, s19, s62
    s_lshl_b32 s24, s19, 11
    s_lshl_b32 s19, s19, 19
    s_lshl_b32 s20, s88, 18
    s_add_u32 s19, s19, s20
    s_add_u32 s22, s56, s19
    s_addc_u32 s23, s57, 0
    s_mov_b32 s4, s22
    s_and_b32 s5, s23, 0xffff
    s_mov_b32 s6, 262144
    s_mov_b32 s7, 0x00020000
    s_cmp_eq_u32 s89, 0
    s_cselect_b32 s22, s34, s36
    s_cselect_b32 s23, s35, s37
    s_lshl_b32 s19, s63, 19
    s_lshl_b32 s21, s88, 11
    s_add_u32 s19, s19, s21
    s_add_u32 s22, s22, s19
    s_addc_u32 s23, s23, 0
    s_mov_b32 s8, s22
    s_and_b32 s9, s23, 0xffff
    s_mov_b32 s10, 522240
    s_mov_b32 s11, 0x00020000
    s_lshl_b32 s20, s88, 10
    s_add_u32 s24, s24, s20
    s_add_u32 s24, s24, 12582912
    s_sub_u32 s17, s16, 4
    v_lshrrev_b32 v1, 3, v0
    v_lshrrev_b32 v2, 4, v0
    v_and_b32 v3, 7, v0
    s_lshl_b32 s18, s17, 5
    v_add_u32 v1, s18, v1
    v_lshlrev_b32 v6, 7, v1
    v_add_u32 v4, 0, v1
    v_lshlrev_b32 v4, 12, v4
    v_add_u32 v5, 0, v2
    v_and_b32 v5, 7, v5
    v_xor_b32 v5, v5, v3
    v_lshlrev_b32 v5, 4, v5
    v_add_u32 v4, v4, v5
    v_subrev_u32 v8, 0, v4
    v_lshlrev_b32 v12, 4, v0
    s_lshl_b32 s19, s17, 12
    v_add_u32 v12, s19, v12
    v_add_u32 v4, 8, v1
    v_lshlrev_b32 v4, 12, v4
    v_add_u32 v5, 4, v2
    v_and_b32 v5, 7, v5
    v_xor_b32 v5, v5, v3
    v_lshlrev_b32 v5, 4, v5
    v_add_u32 v4, v4, v5
    v_subrev_u32 v9, 1024, v4
    v_add_u32 v4, 16, v1
    v_lshlrev_b32 v4, 12, v4
    v_add_u32 v5, 8, v2
    v_and_b32 v5, 7, v5
    v_xor_b32 v5, v5, v3
    v_lshlrev_b32 v5, 4, v5
    v_add_u32 v4, v4, v5
    v_subrev_u32 v10, 2048, v4
    v_add_u32 v4, 24, v1
    v_lshlrev_b32 v4, 12, v4
    v_add_u32 v5, 12, v2
    v_and_b32 v5, 7, v5
    v_xor_b32 v5, v5, v3
    v_lshlrev_b32 v5, 4, v5
    v_add_u32 v4, v4, v5
    v_subrev_u32 v11, 3072, v4
    s_lshl_b32 s21, s17, 12
    s_lshl_b32 s31, s17, 6
    v_add_u32 v199, s31, v0
    s_and_b32 s66, s59, 7
    s_lshl_b32 s31, s65, 3
    s_add_u32 s66, s66, s31
    s_sub_u32 s31, s58, 4
    s_lshl_b32 s31, s31, 3
    s_add_u32 s31, s31, s59
    s_sub_u32 s31, s31, 24
    s_lshl_b32 s31, s31, 1
    s_add_u32 s31, s31, s17
    s_cmp_lt_u32 s65, 28
    s_cselect_b32 s66, s66, s31
    s_cselect_b32 s30, 99, 99
    s_barrier
    s_mov_b32 s20, 0
    s_add_u32 s19, s21, 16384
kx_l2q:
    s_mov_b32 m0, s19
    s_add_u32 s19, s19, 32768
    buffer_load_dwordx4 v8, s[8:11], s20 offen offset:0 lds
    buffer_load_dwordx4 v9, s[8:11], s20 offen offset:1024 lds
    buffer_load_dwordx4 v10, s[8:11], s20 offen offset:2048 lds
    buffer_load_dwordx4 v11, s[8:11], s20 offen offset:3072 lds
    s_add_u32 s20, s20, 128
    s_cmp_lt_u32 s20, 512
    s_cbranch_scc1 kx_l2q
    s_cmp_lg_u32 s16, 4
    s_cbranch_scc1 kx_poll0_done
    v_lshlrev_b32 v20, 7, v3
    s_mov_b64 exec, 0xff
    s_mov_b32 s31, 0
kx_poll0:
    buffer_load_dwordx4 v[24:27], v20, s[68:71], s24 offen sc1
    s_waitcnt vmcnt(0)
    v_xor_b32 v24, s84, v24
    v_xor_b32 v25, s84, v25
    v_xor_b32 v26, s84, v26
    v_xor_b32 v27, s84, v27
    v_or3_b32 v24, v24, v25, v26
    v_or_b32 v24, v24, v27
    v_cmp_ne_u32 vcc, 0, v24
    s_add_u32 s31, s31, 1
    s_nop 1
    s_cmp_eq_u64 vcc, 0
    s_cbranch_scc1 kx_poll0_done
    s_cmp_ge_u32 s31, 1048576
    s_cbranch_scc1 kx_poll0_done
    s_sleep 4
    s_branch kx_poll0
kx_poll0_done:
    s_mov_b64 exec, -1
    s_barrier
    s_mov_b32 s26, 0
    s_mov_b32 s19, s21
kx_l2p:
    s_mov_b32 m0, s19
    s_add_u32 s19, s19, 32768
    buffer_load_dwordx4 v12, s[4:7], s26 offen offset:0 sc1 lds
    buffer_load_dwordx4 v12, s[4:7], s26 offen offset:1024 sc1 lds
    buffer_load_dwordx4 v12, s[4:7], s26 offen offset:2048 sc1 lds
    buffer_load_dwordx4 v12, s[4:7], s26 offen offset:3072 sc1 lds
    s_add_u32 s26, s26, 16384
    s_cmp_lt_u32 s26, 65536
    s_cbranch_scc1 kx_l2p
    s_waitcnt vmcnt(8)
    s_barrier
    s_add_u32 s21, s21, 131072
    s_mov_b32 s25, 4
    s_mov_b32 s22, 4
kx_l2loop:
    s_mov_b32 m0, s21
    s_add_u32 s19, s21, 16384
    buffer_load_dwordx4 v12, s[4:7], s26 offen offset:0 sc1 lds
    buffer_load_dwordx4 v12, s[4:7], s26 offen offset:1024 sc1 lds
    buffer_load_dwordx4 v12, s[4:7], s26 offen offset:2048 sc1 lds
    buffer_load_dwordx4 v12, s[4:7], s26 offen offset:3072 sc1 lds
    s_mov_b32 m0, s19
    s_add_u32 s25, s25, 1
    buffer_load_dwordx4 v8, s[8:11], s20 offen offset:0 lds
    buffer_load_dwordx4 v9, s[8:11], s20 offen offset:1024 lds
    buffer_load_dwordx4 v10, s[8:11], s20 offen offset:2048 lds
    buffer_load_dwordx4 v11, s[8:11], s20 offen offset:3072 lds
    s_add_u32 s20, s20, 128
    s_add_u32 s26, s26, 16384
    s_add_u32 s21, s21, 32768
    s_cmp_eq_u32 s25, 5
    s_cselect_b32 s19, 163840, 0
    s_cselect_b32 s27, 5, 0
    s_sub_u32 s21, s21, s19
    s_sub_u32 s25, s25, s27
    s_add_u32 s22, s22, 1
    s_sub_u32 s31, s22, s30
    s_sub_u32 s31, s31, 1
    s_cmp_lt_u32 s31, 1
    s_cbranch_scc1 kx_l2w28
    s_cmp_lg_u32 s22, 5
    s_cbranch_scc1 kx_l2w16
    s_waitcnt vmcnt(12)
kx_l2w16:
    s_waitcnt vmcnt(16)
kx_l2w28:
    s_waitcnt vmcnt(28)
    s_barrier
    s_cmp_lt_u32 s22, 16
    s_cbranch_scc1 kx_l2loop
    s_waitcnt vmcnt(8)
    s_barrier
    s_waitcnt vmcnt(0)
    s_barrier
    s_cmp_ge_u32 s65, 28
    s_cbranch_scc1 kx_rows
    s_mov_b32 s12, s46
    s_and_b32 s13, s47, 0xffff
    s_mov_b32 s14, 1835008
    s_mov_b32 s15, 0x00020000
    s_mov_b32 s72, s48
    s_and_b32 s73, s49, 0xffff
    s_mov_b32 s74, 1835008
    s_mov_b32 s75, 0x00020000
    s_mov_b32 s76, s50
    s_and_b32 s77, s51, 0xffff
    s_mov_b32 s78, 1835008
    s_mov_b32 s79, 0x00020000
    s_movk_i32 s31, 7168
    v_mul_lo_u32 v5, v199, s31
    s_lshl_b32 s31, s66, 4
    v_add_u32 v5, s31, v5
    v_lshlrev_b32 v4, 2, v199
    s_lshl_b32 s28, s66, 13
    s_add_u32 s29, s28, 4096
    buffer_load_dwordx4 v[200:203], v5, s[12:15], 0 offen
    buffer_load_dwordx4 v[204:207], v5, s[12:15], 0 offen offset:3584
    buffer_load_dwordx4 v[208:211], v5, s[72:75], 0 offen
    buffer_load_dwordx4 v[212:215], v5, s[72:75], 0 offen offset:3584
    buffer_load_dword v216, v4, s[76:79], s28 offen offset:0
    buffer_load_dword v217, v4, s[76:79], s28 offen offset:1024
    buffer_load_dword v218, v4, s[76:79], s28 offen offset:2048
    buffer_load_dword v219, v4, s[76:79], s28 offen offset:3072
    buffer_load_dword v220, v4, s[76:79], s29 offen offset:0
    buffer_load_dword v221, v4, s[76:79], s29 offen offset:1024
    buffer_load_dword v222, v4, s[76:79], s29 offen offset:2048
    buffer_load_dword v223, v4, s[76:79], s29 offen offset:3072
kx_rows:
    s_mov_b32 s72, s32
    s_and_b32 s73, s33, 0xffff
    s_mov_b32 s74, 2097152
    s_mov_b32 s75, 0x00020000
    s_mov_b32 s76, s44
    s_and_b32 s77, s45, 0xffff
    s_mov_b32 s78, 1024
    s_mov_b32 s79, 0x00020000
    s_mov_b32 s80, s52
    s_and_b32 s81, s53, 0xffff
    s_mov_b32 s82, 2097152
    s_mov_b32 s83, 0x00020000
    v_lshlrev_b32 v2, 4, v0
    v_and_b32 v1, 7, v0
    v_lshrrev_b32 v3, 3, v0
    v_lshlrev_b32 v5, 8, v3
    v_lshl_add_u32 v5, v1, 4, v5
    v_and_b32 v6, 4, v3
    v_lshlrev_b32 v6, 4, v6
    v_and_b32 v7, 1, v3
    v_lshl_add_u32 v6, v7, 5, v6
    v_and_b32 v7, 2, v3
    v_lshl_add_u32 v6, v7, 3, v6
    s_lshl_b32 s18, s16, 7
    v_add_u32 v6, s18, v6
    v_lshl_add_u32 v7, v1, 10, v6
    s_lshl_b32 s19, s64, 13
    buffer_load_dwordx4 v[24:27], v7, s[72:75], s19 offen
    buffer_load_dwordx4 v[28:31], v6, s[76:79], 0 offen
    buffer_load_dwordx4 v[8:11], v2, s[76:79], 0 offen
    s_lshl_b32 s21, s63, 19
    s_lshr_b32 s22, s16, 1
    s_lshl_b32 s22, s22, 17
    s_add_u32 s21, s21, s22
    s_and_b32 s22, s16, 1
    s_lshl_b32 s22, s22, 14
    s_add_u32 s21, s21, s22
    s_and_b32 s22, s64, 14
    s_lshl_b32 s22, s22, 10
    s_add_u32 s21, s21, s22
    s_and_b32 s22, s64, 1
    s_lshl_b32 s22, s22, 7
    s_add_u32 s21, s21, s22
    s_add_u32 s21, s21, 4194304
    v_and_b32 v3, 15, v0
    v_lshlrev_b32 v3, 7, v3
    s_lshl_b32 s20, s63, 11
    s_add_u32 s20, s20, 12599296
    v_lshlrev_b32 v74, 5, v1
    v_add_u32 v74, 98304, v74
    s_lshl_b32 s22, s16, 2
    v_add_u32 v73, s22, v74
    s_lshl_b32 s22, s64, 3
    s_sub_u32 s22, 0xffff, s22
    v_sub_u32 v75, s22, v1
    s_waitcnt vmcnt(0)
    v_lshlrev_b32 v64, 16, v28
    v_and_b32 v65, 0xffff0000, v28
    v_lshlrev_b32 v76, 16, v24
    v_and_b32 v77, 0xffff0000, v24
    v_lshlrev_b32 v48, 16, v8
    v_and_b32 v49, 0xffff0000, v8
    v_lshlrev_b32 v66, 16, v29
    v_and_b32 v67, 0xffff0000, v29
    v_lshlrev_b32 v78, 16, v25
    v_and_b32 v79, 0xffff0000, v25
    v_lshlrev_b32 v50, 16, v9
    v_and_b32 v51, 0xffff0000, v9
    v_lshlrev_b32 v68, 16, v30
    v_and_b32 v69, 0xffff0000, v30
    v_lshlrev_b32 v80, 16, v26
    v_and_b32 v81, 0xffff0000, v26
    v_lshlrev_b32 v52, 16, v10
    v_and_b32 v53, 0xffff0000, v10
    v_lshlrev_b32 v70, 16, v31
    v_and_b32 v71, 0xffff0000, v31
    v_lshlrev_b32 v82, 16, v27
    v_and_b32 v83, 0xffff0000, v27
    v_lshlrev_b32 v54, 16, v11
    v_and_b32 v55, 0xffff0000, v11
    v_pk_add_f32 v[48:49], v[48:49], v[50:51]
    v_pk_add_f32 v[52:53], v[52:53], v[54:55]
    v_pk_add_f32 v[48:49], v[48:49], v[52:53]
    v_add_f32 v72, v48, v49
    s_nop 1
    v_add_f32_dpp v72, v72, v72 row_ror:8 row_mask:0xf bank_mask:0xf
    s_nop 1
    v_add_f32_dpp v72, v72, v72 row_ror:4 row_mask:0xf bank_mask:0xf
    s_nop 1
    v_add_f32_dpp v72, v72, v72 row_ror:2 row_mask:0xf bank_mask:0xf
    s_nop 1
    v_add_f32_dpp v72, v72, v72 row_ror:1 row_mask:0xf bank_mask:0xf
    v_mov_b32 v49, v72
    s_nop 1
    v_permlane16_swap_b32 v72, v49
    s_nop 1
    v_add_f32 v72, v72, v49
    v_mov_b32 v49, v72
    s_nop 1
    v_permlane32_swap_b32 v72, v49
    s_nop 1
    v_add_f32 v72, v72, v49
    s_cmp_lg_u32 s16, 0
    s_cbranch_scc1 kx_poll1_done
    s_mov_b64 exec, 0xffff
    s_mov_b32 s31, 0
kx_poll1:
    buffer_load_dwordx4 v[8:11], v3, s[68:71], s20 offen sc1
    s_waitcnt vmcnt(0)
    v_xor_b32 v8, s84, v8
    v_xor_b32 v9, s84, v9
    v_xor_b32 v10, s84, v10
    v_xor_b32 v11, s84, v11
    v_or3_b32 v8, v8, v9, v10
    v_or_b32 v8, v8, v11
    v_cmp_ne_u32 vcc, 0, v8
    s_add_u32 s31, s31, 1
    s_nop 1
    s_cmp_eq_u64 vcc, 0
    s_cbranch_scc1 kx_poll1_done
    s_cmp_ge_u32 s31, 1048576
    s_cbranch_scc1 kx_poll1_done
    s_sleep 4
    s_branch kx_poll1
kx_poll1_done:
    s_mov_b64 exec, -1
    s_barrier
    s_add_u32 s20, s21, 0
    buffer_load_dwordx4 v[8:11], v5, s[68:71], s20 offen sc1
    s_add_u32 s20, s21, 32768
    buffer_load_dwordx4 v[12:15], v5, s[68:71], s20 offen sc1
    s_add_u32 s20, s21, 65536
    buffer_load_dwordx4 v[16:19], v5, s[68:71], s20 offen sc1
    s_add_u32 s20, s21, 98304
    buffer_load_dwordx4 v[20:23], v5, s[68:71], s20 offen sc1
    s_lshl_b32 s20, s64, 11
    s_add_u32 s20, s20, 16777216
    s_lshr_b32 s21, s64, 2
    s_lshl_b32 s21, s21, 7
    s_and_b32 s22, s64, 3
    s_lshl_b32 s22, s22, 3
    s_add_u32 s21, s21, s22
    s_add_u32 s21, s21, 12632064
    v_lshlrev_b32 v5, 13, v0
    s_waitcnt vmcnt(0)
    v_lshlrev_b32 v48, 16, v8
    v_and_b32 v49, 0xffff0000, v8
    v_lshlrev_b32 v50, 16, v12
    v_and_b32 v51, 0xffff0000, v12
    v_lshlrev_b32 v52, 16, v16
    v_and_b32 v53, 0xffff0000, v16
    v_lshlrev_b32 v54, 16, v20
    v_and_b32 v55, 0xffff0000, v20
    v_pk_add_f32 v[48:49], v[48:49], v[50:51]
    v_pk_add_f32 v[52:53], v[52:53], v[54:55]
    v_pk_add_f32 v[48:49], v[48:49], v[76:77]
    v_pk_add_f32 v[48:49], v[48:49], v[52:53] neg_lo:[0,1] neg_hi:[0,1]
    v_cvt_pk_bf16_f32 v32, v48, v49
    v_lshlrev_b32 v40, 16, v32
    v_and_b32 v41, 0xffff0000, v32
    v_lshlrev_b32 v48, 16, v9
    v_and_b32 v49, 0xffff0000, v9
    v_lshlrev_b32 v50, 16, v13
    v_and_b32 v51, 0xffff0000, v13
    v_lshlrev_b32 v52, 16, v17
    v_and_b32 v53, 0xffff0000, v17
    v_lshlrev_b32 v54, 16, v21
    v_and_b32 v55, 0xffff0000, v21
    v_pk_add_f32 v[48:49], v[48:49], v[50:51]
    v_pk_add_f32 v[52:53], v[52:53], v[54:55]
    v_pk_add_f32 v[48:49], v[48:49], v[78:79]
    v_pk_add_f32 v[48:49], v[48:49], v[52:53] neg_lo:[0,1] neg_hi:[0,1]
    v_cvt_pk_bf16_f32 v33, v48, v49
    v_lshlrev_b32 v42, 16, v33
    v_and_b32 v43, 0xffff0000, v33
    v_lshlrev_b32 v48, 16, v10
    v_and_b32 v49, 0xffff0000, v10
    v_lshlrev_b32 v50, 16, v14
    v_and_b32 v51, 0xffff0000, v14
    v_lshlrev_b32 v52, 16, v18
    v_and_b32 v53, 0xffff0000, v18
    v_lshlrev_b32 v54, 16, v22
    v_and_b32 v55, 0xffff0000, v22
    v_pk_add_f32 v[48:49], v[48:49], v[50:51]
    v_pk_add_f32 v[52:53], v[52:53], v[54:55]
    v_pk_add_f32 v[48:49], v[48:49], v[80:81]
    v_pk_add_f32 v[48:49], v[48:49], v[52:53] neg_lo:[0,1] neg_hi:[0,1]
    v_cvt_pk_bf16_f32 v34, v48, v49
    v_lshlrev_b32 v44, 16, v34
    v_and_b32 v45, 0xffff0000, v34
    v_lshlrev_b32 v48, 16, v11
    v_and_b32 v49, 0xffff0000, v11
    v_lshlrev_b32 v50, 16, v15
    v_and_b32 v51, 0xffff0000, v15
    v_lshlrev_b32 v52, 16, v19
    v_and_b32 v53, 0xffff0000, v19
    v_lshlrev_b32 v54, 16, v23
    v_and_b32 v55, 0xffff0000, v23
    v_pk_add_f32 v[48:49], v[48:49], v[50:51]
    v_pk_add_f32 v[52:53], v[52:53], v[54:55]
    v_pk_add_f32 v[48:49], v[48:49], v[82:83]
    v_pk_add_f32 v[48:49], v[48:49], v[52:53] neg_lo:[0,1] neg_hi:[0,1]
    v_cvt_pk_bf16_f32 v35, v48, v49
    v_lshlrev_b32 v46, 16, v35
    v_and_b32 v47, 0xffff0000, v35
    v_pk_add_f32 v[48:49], v[40:41], v[42:43]
    v_pk_mul_f32 v[50:51], v[40:41], v[40:41]
    v_pk_mul_f32 v[52:53], v[40:41], v[64:65]
    v_pk_add_f32 v[54:55], v[44:45], v[46:47]
    v_pk_fma_f32 v[50:51], v[42:43], v[42:43], v[50:51]
    v_pk_fma_f32 v[52:53], v[42:43], v[66:67], v[52:53]
    v_pk_fma_f32 v[50:51], v[44:45], v[44:45], v[50:51]
    v_pk_fma_f32 v[52:53], v[44:45], v[68:69], v[52:53]
    v_pk_fma_f32 v[50:51], v[46:47], v[46:47], v[50:51]
    v_pk_fma_f32 v[52:53], v[46:47], v[70:71], v[52:53]
    v_pk_add_f32 v[48:49], v[48:49], v[54:55]
    v_add_f32 v50, v50, v51
    v_add_f32 v52, v52, v53
    v_add_f32 v48, v48, v49
    v_add_f32_dpp v50, v50, v50 row_ror:8 row_mask:0xf bank_mask:0xf
    v_add_f32_dpp v52, v52, v52 row_ror:8 row_mask:0xf bank_mask:0xf
    v_add_f32_dpp v48, v48, v48 row_ror:8 row_mask:0xf bank_mask:0xf
    v_mov_b32 v51, v50
    v_mov_b32 v53, v52
    v_mov_b32 v49, v48
    s_nop 0
    v_permlane16_swap_b32 v50, v51
    v_permlane16_swap_b32 v52, v53
    v_permlane16_swap_b32 v48, v49
    s_nop 0
    v_add_f32 v50, v50, v51
    v_add_f32 v52, v52, v53
    v_add_f32 v48, v48, v49
    v_mov_b32 v51, v50
    v_mov_b32 v53, v52
    v_mov_b32 v49, v48
    s_nop 0
    v_permlane32_swap_b32 v50, v51
    v_permlane32_swap_b32 v52, v53
    v_permlane32_swap_b32 v48, v49
    s_nop 0
    v_add_f32 v50, v50, v51
    v_add_f32 v52, v52, v53
    v_add_f32 v48, v48, v49
    s_mov_b64 exec, 0xff
    ds_write_b32 v73, v48
    ds_write_b32 v73, v50 offset:256
    ds_write_b32 v73, v52 offset:512
    s_mov_b64 exec, -1
    s_waitcnt lgkmcnt(0)
    s_barrier
    ds_read_b128 v[8:11], v74 offset:0
    ds_read_b128 v[12:15], v74 offset:16
    ds_read_b128 v[16:19], v74 offset:256
    ds_read_b128 v[20:23], v74 offset:272
    ds_read_b128 v[24:27], v74 offset:512
    ds_read_b128 v[28:31], v74 offset:528
    s_waitcnt lgkmcnt(4)
    v_pk_add_f32 v[8:9], v[8:9], v[10:11]
    v_pk_add_f32 v[12:13], v[12:13], v[14:15]
    v_pk_add_f32 v[8:9], v[8:9], v[12:13]
    v_add_f32 v48, v8, v9
    s_waitcnt lgkmcnt(2)
    v_pk_add_f32 v[16:17], v[16:17], v[18:19]
    v_pk_add_f32 v[20:21], v[20:21], v[22:23]
    v_pk_add_f32 v[16:17], v[16:17], v[20:21]
    v_add_f32 v50, v16, v17
    s_waitcnt lgkmcnt(0)
    v_pk_add_f32 v[24:25], v[24:25], v[26:27]
    v_pk_add_f32 v[28:29], v[28:29], v[30:31]
    v_pk_add_f32 v[24:25], v[24:25], v[28:29]
    v_add_f32 v52, v24, v25
    v_mul_f32 v58, 0x3b000000, v48
    v_mul_f32 v50, 0x3b000000, v50
    v_fma_f32 v50, -v58, v58, v50
    v_max_f32 v50, 0, v50
    v_cvt_pk_bf16_f32 v60, v58, v58
    v_and_b32 v60, 0xffff0000, v60
    v_cvt_pk_bf16_f32 v50, v50, v50
    v_and_b32 v50, 0xffff0000, v50
    v_add_f32 v50, 0x3727c5ac, v50
    v_cvt_pk_bf16_f32 v50, v50, v50
    v_and_b32 v50, 0xffff0000, v50
    v_sqrt_f32 v50, v50
    v_fma_f32 v52, -v60, v72, v52
    v_cvt_pk_bf16_f32 v50, v50, v50
    v_and_b32 v50, 0xffff0000, v50
    v_rcp_f32 v58, v50
    v_mov_b32 v57, s84
    v_mul_f32 v48, v52, v58
    v_cvt_pk_bf16_f32 v48, v48, v48
    v_and_b32 v48, 0xffff0000, v48
    v_ashrrev_i32 v49, 31, v48
    v_and_b32 v49, 0x7fff0000, v49
    v_or_b32 v49, 0x80000000, v49
    v_xor_b32 v48, v48, v49
    v_or_b32 v48, v75, v48
    v_mul_f32 v62, v60, v58
    v_sub_f32 v62, 0, v62
    v_max_u32_dpp v56, v48, v48 quad_perm:[1,0,3,2] row_mask:0xf bank_mask:0xf
    s_nop 1
    v_max_u32_dpp v56, v56, v56 quad_perm:[2,3,0,1] row_mask:0xf bank_mask:0xf
    s_nop 1
    v_max_u32_dpp v56, v56, v56 row_half_mirror row_mask:0xf bank_mask:0xf
    s_cmp_lg_u32 s16, 0
    s_cbranch_scc1 kx_nokey
    s_mov_b64 exec, 15
    buffer_store_dwordx2 v[56:57], v5, s[68:71], s21 offen sc1
    s_mov_b64 exec, -1
kx_nokey:
    v_mov_b32 v63, v56
    v_cmp_eq_u32 s[22:23], v56, v48
    v_pk_fma_f32 v[50:51], v[40:41], v[58:59], v[62:63] op_sel_hi:[1,0,0]
    v_cvt_pk_bf16_f32 v36, v50, v51
    v_lshlrev_b32 v50, 16, v36
    v_and_b32 v51, 0xffff0000, v36
    v_pk_add_f32 v[50:51], v[40:41], v[50:51]
    v_cvt_pk_bf16_f32 v24, v50, v51
    v_pk_fma_f32 v[50:51], v[42:43], v[58:59], v[62:63] op_sel_hi:[1,0,0]
    v_cvt_pk_bf16_f32 v37, v50, v51
    v_lshlrev_b32 v50, 16, v37
    v_and_b32 v51, 0xffff0000, v37
    v_pk_add_f32 v[50:51], v[42:43], v[50:51]
    v_cvt_pk_bf16_f32 v25, v50, v51
    v_pk_fma_f32 v[50:51], v[44:45], v[58:59], v[62:63] op_sel_hi:[1,0,0]
    v_cvt_pk_bf16_f32 v38, v50, v51
    v_lshlrev_b32 v50, 16, v38
    v_and_b32 v51, 0xffff0000, v38
    v_pk_add_f32 v[50:51], v[44:45], v[50:51]
    v_cvt_pk_bf16_f32 v26, v50, v51
    v_pk_fma_f32 v[50:51], v[46:47], v[58:59], v[62:63] op_sel_hi:[1,0,0]
    v_cvt_pk_bf16_f32 v39, v50, v51
    v_lshlrev_b32 v50, 16, v39
    v_and_b32 v51, 0xffff0000, v39
    v_pk_add_f32 v[50:51], v[46:47], v[50:51]
    v_cvt_pk_bf16_f32 v27, v50, v51
    s_mov_b64 exec, s[22:23]
    buffer_store_dwordx4 v[36:39], v6, s[68:71], s20 offen sc1
    buffer_store_dwordx4 v[32:35], v6, s[68:71], s20 offen offset:1024 sc1
    ds_write_b128 v6, v[24:27] offset:32768
    s_not_b64 exec, exec
    buffer_store_dwordx4 v[24:27], v7, s[80:83], s19 offen
    s_mov_b64 exec, -1
    s_waitcnt lgkmcnt(0)
kx_notbest:
    s_cmp_lt_u32 s16, 4
    s_cbranch_scc1 kx_exit
    s_cmp_lt_u32 s65, 28
    s_cbranch_scc1 kx_keys
    s_cmp_ge_u32 s16, 6
    s_cbranch_scc1 kx_exit
kx_keys:
    s_and_b32 s20, s64, 3
    s_lshl_b32 s20, s20, 13
    s_add_u32 s20, s20, 12632064
    v_lshlrev_b32 v3, 7, v0
    v_mov_b32 v5, 98816
    s_cmp_lg_u32 s16, 4
    s_cbranch_scc1 kx_keywait
    s_mov_b32 s31, 0
kx_poll2:
    buffer_load_dwordx4 v[8:11], v3, s[68:71], s20 offen sc1
    buffer_load_dwordx4 v[12:15], v3, s[68:71], s20 offen offset:16 sc1
    s_waitcnt vmcnt(0)
    v_xor_b32 v9, s84, v9
    v_xor_b32 v11, s84, v11
    v_xor_b32 v13, s84, v13
    v_xor_b32 v15, s84, v15
    v_or3_b32 v4, v9, v11, v13
    v_or_b32 v4, v4, v15
    v_cmp_ne_u32 vcc, 0, v4
    s_add_u32 s31, s31, 1
    s_nop 1
    s_cmp_eq_u64 vcc, 0
    s_cbranch_scc1 kx_poll2_done
    s_cmp_ge_u32 s31, 1048576
    s_cbranch_scc1 kx_poll2_done
    s_sleep 4
    s_branch kx_poll2
kx_poll2_done:
    v_max_u32 v64, v8, v10
    v_max3_u32 v64, v64, v12, v14
    s_nop 1
    v_max_u32_dpp v64, v64, v64 row_ror:8 row_mask:0xf bank_mask:0xf
    s_nop 1
    v_max_u32_dpp v64, v64, v64 row_ror:4 row_mask:0xf bank_mask:0xf
    s_nop 1
    v_max_u32_dpp v64, v64, v64 row_ror:2 row_mask:0xf bank_mask:0xf
    s_nop 1
    v_max_u32_dpp v64, v64, v64 row_ror:1 row_mask:0xf bank_mask:0xf
    v_mov_b32 v65, v64
    s_nop 1
    v_permlane16_swap_b32 v64, v65
    s_nop 1
    v_max_u32 v64, v64, v65
    v_mov_b32 v65, v64
    s_nop 1
    v_permlane32_swap_b32 v64, v65
    s_nop 1
    v_max_u32 v64, v64, v65
    ds_write_b32 v5, v64
    s_waitcnt lgkmcnt(0)
kx_keywait:
    s_barrier
    ds_read_b32 v64, v5
    ds_read_b128 v[24:27], v2 offset:32768
    s_waitcnt lgkmcnt(0)
    v_and_b32 v66, 0xffff, v64
    v_sub_u32 v66, 0xffff, v66
    v_lshrrev_b32 v67, 3, v66
    v_lshlrev_b32 v67, 11, v67
    s_cmp_lg_u32 s16, 5
    s_cbranch_scc1 kx_noparked
    v_and_b32 v4, 0xffff, v63
    v_sub_u32 v4, 0xffff, v4
    v_lshlrev_b32 v4, 10, v4
    v_add_u32 v4, v4, v2
    v_cmp_ne_u32 vcc, v63, v64
    s_and_saveexec_b64 s[22:23], vcc
    s_cbranch_execz kx_parkskip
    buffer_store_dwordx4 v[24:27], v4, s[80:83], 0 offen
kx_parkskip:
    s_mov_b64 exec, -1
kx_noparked:
    s_mov_b32 s20, 16777216
    s_cmp_ge_u32 s65, 28
    s_cbranch_scc1 kx_final
    v_lshlrev_b32 v4, 2, v199
    v_add_u32 v68, v67, v4
    s_mov_b32 s31, 0
kx_poll4:
    buffer_load_dword v75, v68, s[68:71], s20 offen sc1
    s_waitcnt vmcnt(0)
    v_cmp_eq_u32 vcc, -1, v75
    s_add_u32 s31, s31, 1
    s_nop 1
    s_cmp_eq_u64 vcc, 0
    s_cbranch_scc1 kx_poll4_done
    s_cmp_ge_u32 s31, 1048576
    s_cbranch_scc1 kx_poll4_done
    s_sleep 4
    s_branch kx_poll4
kx_poll4_done:
    s_mov_b32 s22, 0x05040100
    s_mov_b32 s23, 0x07060302
    v_perm_b32 v32, v204, v200, s22
    v_perm_b32 v33, v204, v200, s23
    v_perm_b32 v34, v205, v201, s22
    v_perm_b32 v35, v205, v201, s23
    v_perm_b32 v36, v206, v202, s22
    v_perm_b32 v37, v206, v202, s23
    v_perm_b32 v38, v207, v203, s22
    v_perm_b32 v39, v207, v203, s23
    v_perm_b32 v40, v212, v208, s22
    v_perm_b32 v41, v212, v208, s23
    v_perm_b32 v42, v213, v209, s22
    v_perm_b32 v43, v213, v209, s23
    v_perm_b32 v44, v214, v210, s22
    v_perm_b32 v45, v214, v210, s23
    v_perm_b32 v46, v215, v211, s22
    v_perm_b32 v47, v215, v211, s23
    v_dot2_f32_bf16 v48, v32, v75, 0
    v_dot2_f32_bf16 v49, v33, v75, 0
    v_dot2_f32_bf16 v50, v34, v75, 0
    v_dot2_f32_bf16 v51, v35, v75, 0
    v_dot2_f32_bf16 v52, v36, v75, 0
    v_dot2_f32_bf16 v53, v37, v75, 0
    v_dot2_f32_bf16 v54, v38, v75, 0
    v_dot2_f32_bf16 v55, v39, v75, 0
    v_dot2_f32_bf16 v56, v40, v75, 0
    v_dot2_f32_bf16 v57, v41, v75, 0
    v_dot2_f32_bf16 v58, v42, v75, 0
    v_dot2_f32_bf16 v59, v43, v75, 0
    v_dot2_f32_bf16 v60, v44, v75, 0
    v_dot2_f32_bf16 v61, v45, v75, 0
    v_dot2_f32_bf16 v62, v46, v75, 0
    v_dot2_f32_bf16 v63, v47, v75, 0
    s_nop 2
    v_permlane32_swap_b32 v48, v56
    v_permlane32_swap_b32 v49, v57
    v_permlane32_swap_b32 v50, v58
    v_permlane32_swap_b32 v51, v59
    v_permlane32_swap_b32 v52, v60
    v_permlane32_swap_b32 v53, v61
    v_permlane32_swap_b32 v54, v62
    v_permlane32_swap_b32 v55, v63
    s_nop 1
    v_add_f32 v48, v48, v56
    v_add_f32 v49, v49, v57
    v_add_f32 v50, v50, v58
    v_add_f32 v51, v51, v59
    v_add_f32 v52, v52, v60
    v_add_f32 v53, v53, v61
    v_add_f32 v54, v54, v62
    v_add_f32 v55, v55, v63
    s_nop 1
    v_permlane16_swap_b32 v48, v52
    v_permlane16_swap_b32 v49, v53
    v_permlane16_swap_b32 v50, v54
    v_permlane16_swap_b32 v51, v55
    s_nop 1
    v_add_f32 v48, v48, v52
    v_add_f32 v49, v49, v53
    v_add_f32 v50, v50, v54
    v_add_f32 v51, v51, v55
    s_nop 0
    v_add_f32_dpp v48, v48, v48 row_ror:8 row_mask:0xf bank_mask:0xf
    v_add_f32_dpp v49, v49, v49 row_ror:8 row_mask:0xf bank_mask:0xf
    v_add_f32_dpp v50, v50, v50 row_ror:8 row_mask:0xf bank_mask:0xf
    v_add_f32_dpp v51, v51, v51 row_ror:8 row_mask:0xf bank_mask:0xf
    s_nop 0
    v_add_f32_dpp v48, v48, v48 row_ror:4 row_mask:0xf bank_mask:0xf
    v_add_f32_dpp v49, v49, v49 row_ror:4 row_mask:0xf bank_mask:0xf
    v_add_f32_dpp v50, v50, v50 row_ror:4 row_mask:0xf bank_mask:0xf
    v_add_f32_dpp v51, v51, v51 row_ror:4 row_mask:0xf bank_mask:0xf
    s_nop 0
    v_add_f32_dpp v48, v48, v48 row_ror:2 row_mask:0xf bank_mask:0xf
    v_add_f32_dpp v49, v49, v49 row_ror:2 row_mask:0xf bank_mask:0xf
    v_add_f32_dpp v50, v50, v50 row_ror:2 row_mask:0xf bank_mask:0xf
    v_add_f32_dpp v51, v51, v51 row_ror:2 row_mask:0xf bank_mask:0xf
    s_nop 0
    v_add_f32_dpp v48, v48, v48 row_ror:1 row_mask:0xf bank_mask:0xf
    v_add_f32_dpp v49, v49, v49 row_ror:1 row_mask:0xf bank_mask:0xf
    v_add_f32_dpp v50, v50, v50 row_ror:1 row_mask:0xf bank_mask:0xf
    v_add_f32_dpp v51, v51, v51 row_ror:1 row_mask:0xf bank_mask:0xf
    s_lshl_b32 s21, s17, 6
    s_add_u32 s21, s21, 98560
    v_lshrrev_b32 v7, 4, v0
    v_lshlrev_b32 v7, 4, v7
    v_add_u32 v6, s21, v7
    ds_write_b128 v6, v[48:51]
    v_and_b32 v7, 7, v0
    v_lshlrev_b32 v7, 2, v7
    v_add_u32 v7, 98560, v7
    s_waitcnt lgkmcnt(0)
    s_barrier
    ds_read_b32 v48, v7 offset:0
    ds_read_b32 v52, v7 offset:32
    ds_read_b32 v49, v7 offset:64
    ds_read_b32 v53, v7 offset:96
    ds_read_b32 v50, v7 offset:128
    ds_read_b32 v54, v7 offset:160
    ds_read_b32 v51, v7 offset:192
    ds_read_b32 v55, v7 offset:224
    s_waitcnt lgkmcnt(0)
    v_add_f32 v48, v48, v49
    v_add_f32 v50, v50, v51
    v_add_f32 v52, v52, v53
    v_add_f32 v54, v54, v55
    v_add_f32 v48, v48, v50
    v_add_f32 v52, v52, v54
    v_cvt_pk_bf16_f32 v48, v48, v48
    v_and_b32 v48, 0xffff0000, v48
    v_cvt_pk_bf16_f32 v52, v52, v52
    v_and_b32 v52, 0xffff0000, v52
    v_mul_f32 v49, 0xbfb8aa3b, v48
    v_exp_f32 v49, v49
    s_nop 0
    v_add_f32 v49, 1.0, v49
    v_rcp_f32 v49, v49
    s_nop 0
    v_mul_f32 v48, v48, v49
    v_cvt_pk_bf16_f32 v48, v48, v48
    v_and_b32 v48, 0xffff0000, v48
    v_mul_f32 v48, v48, v52
    v_cvt_pk_bf16_f32 v48, v48, v48
    v_and_b32 v48, 0xffff0000, v48
    s_nop 0
    v_readlane_b32 s4, v48, 0
    v_readlane_b32 s5, v48, 1
    v_readlane_b32 s6, v48, 2
    v_readlane_b32 s7, v48, 3
    v_readlane_b32 s8, v48, 4
    v_readlane_b32 s9, v48, 5
    v_readlane_b32 s10, v48, 6
    v_readlane_b32 s11, v48, 7
    v_mov_b32 v50, 0
    v_mov_b32 v51, 0
    v_lshlrev_b32 v52, 16, v216
    v_and_b32 v53, 0xffff0000, v216
    v_fmac_f32 v50, s4, v52
    v_fmac_f32 v51, s4, v53
    v_lshlrev_b32 v52, 16, v217
    v_and_b32 v53, 0xffff0000, v217
    v_fmac_f32 v50, s5, v52
    v_fmac_f32 v51, s5, v53
    v_lshlrev_b32 v52, 16, v218
    v_and_b32 v53, 0xffff0000, v218
    v_fmac_f32 v50, s6, v52
    v_fmac_f32 v51, s6, v53
    v_lshlrev_b32 v52, 16, v219
    v_and_b32 v53, 0xffff0000, v219
    v_fmac_f32 v50, s7, v52
    v_fmac_f32 v51, s7, v53
    v_lshlrev_b32 v52, 16, v220
    v_and_b32 v53, 0xffff0000, v220
    v_fmac_f32 v50, s8, v52
    v_fmac_f32 v51, s8, v53
    v_lshlrev_b32 v52, 16, v221
    v_and_b32 v53, 0xffff0000, v221
    v_fmac_f32 v50, s9, v52
    v_fmac_f32 v51, s9, v53
    v_lshlrev_b32 v52, 16, v222
    v_and_b32 v53, 0xffff0000, v222
    v_fmac_f32 v50, s10, v52
    v_fmac_f32 v51, s10, v53
    v_lshlrev_b32 v52, 16, v223
    v_and_b32 v53, 0xffff0000, v223
    v_fmac_f32 v50, s11, v52
    v_fmac_f32 v51, s11, v53
    v_lshlrev_b32 v6, 3, v199
    s_lshl_b32 s20, s66, 11
    s_add_u32 s20, s20, 15728640
    buffer_store_dwordx2 v[50:51], v6, s[68:71], s20 offen sc1
    s_endpgm
kx_final:
    v_lshrrev_b32 v5, 4, v0
    v_lshlrev_b32 v3, 2, v5
    s_lshl_b32 s19, s66, 4
    v_add_u32 v3, s19, v3
    v_add_u32 v68, v67, v3
    s_mov_b32 s31, 0
kx_poll5:
    buffer_load_dword v75, v68, s[68:71], s20 offen sc1
    buffer_load_dword v69, v68, s[68:71], s20 offen offset:1024 sc1
    s_waitcnt vmcnt(0)
    v_max_u32 v4, v69, v75
    v_cmp_eq_u32 vcc, -1, v4
    s_add_u32 s31, s31, 1
    s_nop 1
    s_cmp_eq_u64 vcc, 0
    s_cbranch_scc1 kx_poll5_done
    s_cmp_ge_u32 s31, 1048576
    s_cbranch_scc1 kx_poll5_done
    s_sleep 4
    s_branch kx_poll5
kx_poll5_done:
    v_and_b32 v52, 0xffff0000, v64
    v_ashrrev_i32 v53, 31, v52
    v_not_b32 v53, v53
    v_and_b32 v53, 0x7fff0000, v53
    v_or_b32 v53, 0x80000000, v53
    v_xor_b32 v52, v52, v53
    v_mul_f32 v53, 0xbfb8aa3b, v52
    v_exp_f32 v53, v53
    s_nop 0
    v_add_f32 v53, 1.0, v53
    v_rcp_f32 v53, v53
    s_nop 0
    v_cvt_pk_bf16_f32 v44, v53, v53
    v_and_b32 v44, 0xffff0000, v44
    v_lshlrev_b32 v40, 16, v69
    v_and_b32 v41, 0xffff0000, v69
    v_lshlrev_b32 v42, 16, v75
    v_and_b32 v43, 0xffff0000, v75
    v_lshlrev_b32 v45, 10, v66
    v_add_u32 v45, v45, v3
    v_lshlrev_b32 v1, 11, v0
    s_lshl_b32 s19, s66, 5
    v_add_u32 v1, s19, v1
    v_cmp_gt_u32 vcc, 32, v0
    v_mov_b32 v6, 0x40000000
    v_cndmask_b32 v6, v6, v1, vcc
    s_mov_b32 s24, 15728640
    s_mov_b32 s25, 15859712
    s_mov_b32 s26, 15990784
    s_mov_b32 s27, 16121856
    s_mov_b32 s31, 0
kx_poll3:
    buffer_load_dwordx4 v[8:11], v1, s[68:71], s24 offen sc1
    buffer_load_dwordx4 v[12:15], v1, s[68:71], s24 offen offset:16 sc1
    buffer_load_dwordx4 v[16:19], v1, s[68:71], s25 offen sc1
    buffer_load_dwordx4 v[20:23], v1, s[68:71], s25 offen offset:16 sc1
    buffer_load_dwordx4 v[24:27], v1, s[68:71], s26 offen sc1
    buffer_load_dwordx4 v[28:31], v1, s[68:71], s26 offen offset:16 sc1
    buffer_load_dwordx4 v[32:35], v6, s[68:71], s27 offen sc1
    buffer_load_dwordx4 v[36:39], v6, s[68:71], s27 offen offset:16 sc1
    s_waitcnt vmcnt(0)
    v_max3_u32 v4, v8, v9, v10
    v_max3_u32 v4, v4, v11, v12
    v_max3_u32 v4, v4, v13, v14
    v_max3_u32 v4, v4, v15, v16
    v_max3_u32 v4, v4, v17, v18
    v_max3_u32 v4, v4, v19, v20
    v_max3_u32 v4, v4, v21, v22
    v_max3_u32 v4, v4, v23, v24
    v_max3_u32 v4, v4, v25, v26
    v_max3_u32 v4, v4, v27, v28
    v_max3_u32 v4, v4, v29, v30
    v_max3_u32 v4, v4, v31, v32
    v_max3_u32 v4, v4, v33, v34
    v_max3_u32 v4, v4, v35, v36
    v_max3_u32 v4, v4, v37, v38
    v_max_u32 v4, v4, v39
    v_cmp_eq_u32 vcc, -1, v4
    s_add_u32 s31, s31, 1
    s_nop 1
    s_cmp_eq_u64 vcc, 0
    s_cbranch_scc1 kx_poll3_done
    s_cmp_ge_u32 s31, 1048576
    s_cbranch_scc1 kx_poll3_done
    s_sleep 4
    s_branch kx_poll3
kx_poll3_done:
    v_pk_add_f32 v[8:9], v[8:9], v[16:17]
    v_pk_add_f32 v[24:25], v[24:25], v[32:33]
    v_pk_add_f32 v[10:11], v[10:11], v[18:19]
    v_pk_add_f32 v[26:27], v[26:27], v[34:35]
    v_pk_add_f32 v[12:13], v[12:13], v[20:21]
    v_pk_add_f32 v[28:29], v[28:29], v[36:37]
    v_pk_add_f32 v[14:15], v[14:15], v[22:23]
    v_pk_add_f32 v[30:31], v[30:31], v[38:39]
    v_pk_add_f32 v[8:9], v[8:9], v[24:25]
    v_pk_add_f32 v[10:11], v[10:11], v[26:27]
    v_pk_add_f32 v[12:13], v[12:13], v[28:29]
    v_pk_add_f32 v[14:15], v[14:15], v[30:31]
    s_nop 1
    v_permlane32_swap_b32 v8, v12
    v_permlane32_swap_b32 v9, v13
    v_permlane32_swap_b32 v10, v14
    v_permlane32_swap_b32 v11, v15
    s_nop 1
    v_add_f32 v8, v8, v12
    v_add_f32 v9, v9, v13
    v_add_f32 v10, v10, v14
    v_add_f32 v11, v11, v15
    s_nop 1
    v_permlane16_swap_b32 v8, v10
    v_permlane16_swap_b32 v9, v11
    s_nop 1
    v_add_f32 v8, v8, v10
    v_add_f32 v9, v9, v11
    s_nop 1
    v_add_f32_dpp v8, v8, v8 row_ror:8 row_mask:0xf bank_mask:0xf
    v_add_f32_dpp v9, v9, v9 row_ror:8 row_mask:0xf bank_mask:0xf
    s_nop 1
    v_add_f32_dpp v8, v8, v8 row_ror:4 row_mask:0xf bank_mask:0xf
    v_add_f32_dpp v9, v9, v9 row_ror:4 row_mask:0xf bank_mask:0xf
    s_nop 1
    v_add_f32_dpp v8, v8, v8 row_ror:2 row_mask:0xf bank_mask:0xf
    v_add_f32_dpp v9, v9, v9 row_ror:2 row_mask:0xf bank_mask:0xf
    s_nop 1
    v_add_f32_dpp v8, v8, v8 row_ror:1 row_mask:0xf bank_mask:0xf
    v_add_f32_dpp v9, v9, v9 row_ror:1 row_mask:0xf bank_mask:0xf
    v_cvt_pk_bf16_f32 v8, v8, v8
    v_and_b32 v8, 0xffff0000, v8
    v_mul_f32 v8, v8, v44
    v_cvt_pk_bf16_f32 v8, v8, v8
    v_and_b32 v8, 0xffff0000, v8
    v_add_f32 v8, v8, v42
    v_cvt_pk_bf16_f32 v8, v8, v8
    v_and_b32 v8, 0xffff0000, v8
    v_add_f32 v8, v8, v40
    v_cvt_pk_bf16_f32 v9, v9, v9
    v_and_b32 v9, 0xffff0000, v9
    v_mul_f32 v9, v9, v44
    v_cvt_pk_bf16_f32 v9, v9, v9
    v_and_b32 v9, 0xffff0000, v9
    v_add_f32 v9, v9, v43
    v_cvt_pk_bf16_f32 v9, v9, v9
    v_and_b32 v9, 0xffff0000, v9
    v_add_f32 v9, v9, v41
    v_cvt_pk_bf16_f32 v8, v8, v9
    v_and_b32 v6, 15, v0
    v_cmp_eq_u32 vcc, 0, v6
    s_and_saveexec_b64 s[30:31], vcc
    buffer_store_dword v8, v45, s[80:83], 0 offen
    s_mov_b64 exec, -1
kx_exit:
    s_endpgm
kx_end:
.section .rodata,"a"
.p2align 6
.amdhsa_kernel kx_kernel
  .amdhsa_next_free_vgpr 224
  .amdhsa_next_free_sgpr 96
  .amdhsa_accum_offset 224
  .amdhsa_group_segment_fixed_size 0
  .amdhsa_kernarg_size 104
  .amdhsa_user_sgpr_count 2
  .amdhsa_user_sgpr_kernarg_segment_ptr 1
  .amdhsa_system_sgpr_workgroup_id_x 1
  .amdhsa_float_denorm_mode_32 3
.end_amdhsa_kernel
```
